```python
import torch

def _softmax(x, axis=-1):
    return torch.softmax(x, dim=axis)
def _gelu(x):
    return torch.nn.functional.gelu(x, approximate="tanh")
def _silu(x):
    return torch.nn.functional.silu(x)
def _sigmoid(x):
    return torch.sigmoid(x)
def _layernorm(x, axis=-1, eps=1e-5):
    m = x.mean(dim=axis, keepdim=True)
    v = x.var(dim=axis, keepdim=True, unbiased=False)
    return (x - m) / torch.sqrt(v + eps)
def _scatter_add(tgt, idx, src, axis=0):
    return tgt.clone().index_add_(axis, idx, src)
def _segment_sum(src, seg, n):
    out = torch.zeros((n,) + src.shape[1:], dtype=src.dtype)
    return out.index_add_(0, seg, src)
def _pad(x, pw):
    flat = tuple(v for pair in reversed(pw) for v in pair)
    return torch.nn.functional.pad(x, flat)

kernel_name = 'concat_heads__mha_block__softmax_full_mha__prompt'

def setup_inputs():

    _w = (lambda a: (lambda t: t.to(torch.bfloat16) if t.is_floating_point() else t)(torch.as_tensor(a)))
    def _A_setup():
        B, S, D, H = 1, 2048, 512, 32
        return {
            "x": _w((lambda *s: torch.randn(*s, dtype=torch.bfloat16) * 0.2)(B, S, D)),
            "wqkv": _w((lambda *s: torch.randn(*s, dtype=torch.bfloat16) * 0.2)(D, 3 * D)),
            "wo": _w((lambda *s: torch.randn(*s, dtype=torch.bfloat16) * 0.05)(D, D)),
        }
    _A_in = _A_setup()

    def _B_setup():
        B, S, D = 1, 2048, 512
        return {
            "x": _w((lambda *s: torch.randn(*s, dtype=torch.bfloat16) * 0.2)(B, S, D)),
            "wqkv": _w((lambda *s: torch.randn(*s, dtype=torch.bfloat16) * 0.2)(D, 3 * D)),
            "wo": _w((lambda *s: torch.randn(*s, dtype=torch.bfloat16) * 0.05)(D, D)),
        }
    _B_in = _B_setup()

    return {
        "A_x": _A_in["x"],
        "A_wqkv": _A_in["wqkv"],
        "A_wo": _A_in["wo"],
        "B_x": _B_in["x"],
        "B_wqkv": _B_in["wqkv"],
        "B_wo": _B_in["wo"],
    }

def reference(A_x, A_wqkv, A_wo, B_x, B_wqkv, B_wo):
    def _A_ref(x, wqkv, wo):
        B, S, D = x.shape
        H = 32
        Dh = D // H
        qkv = (lambda x, *d: x.permute(*d))((x @ wqkv).reshape(B, S, 3, H, Dh), 2, 0, 3, 1, 4)
        q, k, v = qkv[0], qkv[1], qkv[2]
        scores = torch.einsum("bhqd,bhkd->bhqk", q, k) * (Dh ** -0.5)
        p = _softmax(scores, axis=-1)
        o = torch.einsum("bhqk,bhkd->bhqd", p, v)
        return (lambda x, *d: x.permute(*d))(o, 0, 2, 1, 3).reshape(B, S, D) @ wo

    def _B_ref(x, wqkv, wo):
        B, S, D = x.shape
        H = 32; Dh = D // H
        qkv = (lambda x, *d: x.permute(*d))((x @ wqkv).reshape(B, S, 3, H, Dh), 2, 0, 3, 1, 4)
        q, k, v = qkv[0], qkv[1], qkv[2]
        scale = Dh ** -0.5
        scores = torch.einsum("bhqd,bhkd->bhqk", q, k) * scale
        p = _softmax(scores, axis=-1)
        o = torch.einsum("bhqk,bhkd->bhqd", p, v)
        return (lambda x, *d: x.permute(*d))(o, 0, 2, 1, 3).reshape(B, S, D) @ wo

    a = _A_ref(A_x, A_wqkv, A_wo)
    b = _B_ref(B_x, B_wqkv, B_wo)
    return torch.concatenate([a, b], axis=-1)
```

```asm
; @launch grid=(256,1,1) block=(512,1,1) lds=163840
.amdgcn_target "amdgcn-amd-amdhsa--gfx950"
.text
.globl concat_heads__mha_block__softmax_full_mha__prompt_kernel
.p2align 8
.type concat_heads__mha_block__softmax_full_mha__prompt_kernel,@function
concat_heads__mha_block__softmax_full_mha__prompt_kernel:
  s_cmp_ge_u32 s2, 256
  s_cbranch_scc1 concat_heads__mha_block__softmax_full_mha__prompt_kernel_end
  s_and_b32 s29, s2, 7
  s_lshr_b32 s30, s2, 3
  s_lshr_b32 s24, s29, 2
  s_mul_i32 s31, s24, 24
  s_load_dwordx4 s[4:7], s[0:1], s31
  s_load_dwordx2 s[36:37], s[0:1], 64
  s_add_u32 s31, s31, 16
  s_load_dwordx2 s[32:33], s[0:1], s31
  s_load_dwordx2 s[34:35], s[0:1], 48
  v_lshrrev_b32 v1, 6, v0
  s_and_b32 s29, s29, 3
  s_lshl_b32 s29, s29, 2
  v_readfirstlane_b32 s3, v1
  s_and_b32 s25, s30, 15
  s_lshr_b32 s30, s30, 4
  s_lshr_b32 s29, s29, 1
  s_add_u32 s26, s29, s30
  v_and_b32 v0, 63, v0
  s_lshr_b32 s27, s3, 2
  s_and_b32 s28, s3, 3
  s_lshl_b32 s29, s26, 8
  s_lshl_b32 s30, s3, 5
  s_add_u32 s29, s29, s30
  s_lshl_b32 s29, s29, 10
  v_lshrrev_b32 v248, 4, v0
  v_and_b32 v249, 7, v0
  v_xor_b32 v248, v248, v249
  v_lshlrev_b32 v248, 4, v248
  v_lshrrev_b32 v249, 3, v0
  v_lshl_add_u32 v249, v249, 10, s29
  v_xor_b32 v250, 64, v248
  v_add_u32 v4, v249, v248
  v_add_u32 v5, v249, v250
  v_add_u32 v5, 7168, v5
  v_add_u32 v6, 14336, v4
  v_add_u32 v7, 14336, v5
  s_lshr_b32 s40, s25, 1
  s_add_u32 s40, s40, s26
  s_lshl_b32 s40, s40, 1
  s_and_b32 s41, s25, 1
  s_add_u32 s40, s40, s41
  s_lshl_b32 s40, s40, 1
  s_lshl_b32 s42, s3, 12
  s_mul_i32 s43, s3, 1536
  s_add_u32 s43, s43, 98304
  s_mov_b32 s46, -1
  s_mov_b32 s47, 0
  s_mul_i32 s29, s3, 96
  s_lshl_b32 s30, s25, 6
  v_add_u32 v248, s29, v0
  v_mul_u32_u24 v249, 1366, v248
  v_lshrrev_b32 v249, 16, v249
  v_mul_u32_u24 v250, 48, v249
  v_sub_u32 v250, v248, v250
  v_bfe_u32 v251, v250, 2, 2
  v_lshl_add_u32 v251, v249, 2, v251
  v_mul_u32_u24 v8, 3072, v251
  v_lshrrev_b32 v251, 4, v250
  v_lshl_add_u32 v8, v251, 10, v8
  v_and_b32 v249, 2, v249
  v_xor_b32 v250, v250, v249
  v_and_b32 v250, 3, v250
  v_lshl_add_u32 v8, v250, 4, v8
  v_add_u32 v8, s30, v8
  v_add_u32 v248, s29, v0
  v_add_u32 v248, 64, v248
  v_mul_u32_u24 v249, 1366, v248
  v_lshrrev_b32 v249, 16, v249
  v_mul_u32_u24 v250, 48, v249
  v_sub_u32 v250, v248, v250
  v_bfe_u32 v251, v250, 2, 2
  v_lshl_add_u32 v251, v249, 2, v251
  v_mul_u32_u24 v9, 3072, v251
  v_lshrrev_b32 v251, 4, v250
  v_lshl_add_u32 v9, v251, 10, v9
  v_and_b32 v249, 2, v249
  v_xor_b32 v250, v250, v249
  v_and_b32 v250, 3, v250
  v_lshl_add_u32 v9, v250, 4, v9
  s_sub_u32 s30, s30, 1024
  v_add_u32 v9, s30, v9
  s_waitcnt lgkmcnt(0)
  s_mov_b32 s8, s4
  s_mov_b32 s9, s5
  s_mov_b32 s10, 2097152
  s_mov_b32 s11, 0x20000
  s_mov_b32 s12, s6
  s_mov_b32 s13, s7
  s_mov_b32 s14, 1572864
  s_mov_b32 s15, 0x20000
  s_add_u32 s41, s40, 0
  s_and_b32 s41, s41, 7
  s_add_u32 m0, s42, 0
  s_lshl_b32 s44, s41, 7
  buffer_load_dwordx4 v4, s[8:11], s44 offen offset:0 lds
  buffer_load_dwordx4 v5, s[8:11], s44 offen offset:1024 lds
  buffer_load_dwordx4 v6, s[8:11], s44 offen offset:2048 lds
  buffer_load_dwordx4 v7, s[8:11], s44 offen offset:3072 lds
  s_add_u32 s41, s40, 0
  s_and_b32 s41, s41, 7
  s_add_u32 m0, s43, 0
  s_mul_i32 s45, s41, 196608
  buffer_load_dwordx4 v8, s[12:15], s45 offen lds
  s_mov_b64 exec, s[46:47]
  buffer_load_dwordx4 v9, s[12:15], s45 offen offset:1024 lds
  s_mov_b64 exec, -1
  s_add_u32 s41, s40, 1
  s_and_b32 s41, s41, 7
  s_add_u32 m0, s42, 32768
  s_lshl_b32 s44, s41, 7
  buffer_load_dwordx4 v4, s[8:11], s44 offen offset:0 lds
  buffer_load_dwordx4 v5, s[8:11], s44 offen offset:1024 lds
  buffer_load_dwordx4 v6, s[8:11], s44 offen offset:2048 lds
  buffer_load_dwordx4 v7, s[8:11], s44 offen offset:3072 lds
  s_add_u32 s41, s40, 1
  s_and_b32 s41, s41, 7
  s_add_u32 m0, s43, 12288
  s_mul_i32 s45, s41, 196608
  buffer_load_dwordx4 v8, s[12:15], s45 offen lds
  s_mov_b64 exec, s[46:47]
  buffer_load_dwordx4 v9, s[12:15], s45 offen offset:1024 lds
  s_mov_b64 exec, -1
  s_mov_b32 s16, s36
  s_mov_b32 s17, s37
  s_mov_b32 s18, 14680064
  s_mov_b32 s19, 0x20000
  s_mov_b32 s20, s34
  s_mov_b32 s21, s35
  s_mov_b32 s22, 4194304
  s_mov_b32 s23, 0x20000
  s_lshl_b32 s30, s24, 4
  s_add_u32 s30, s30, s25
  s_lshl_b32 s31, s30, 17
  s_lshl_b32 s50, s30, 11
  s_add_u32 s50, s50, 12582912
  s_add_u32 s29, s50, 1024
  s_load_dword s51, s[36:37], s29
  s_lshl_b32 s29, s24, 3
  s_add_u32 s29, s29, s26
  s_lshl_b32 s29, s29, 12
  s_add_u32 s38, s29, 12648448
  s_add_u32 s29, s38, 2048
  s_load_dword s39, s[36:37], s29
  s_lshl_b32 s48, s27, 16
  s_add_u32 s48, s48, s31
  s_add_u32 s57, s31, 4194304
  s_lshl_b32 s49, s26, 3
  s_lshl_b32 s29, s28, 1
  s_add_u32 s49, s49, s29
  v_bfe_u32 v248, v0, 1, 3
  v_lshrrev_b32 v249, 4, v0
  v_xor_b32 v248, v248, v249
  v_lshlrev_b32 v248, 4, v248
  v_and_b32 v250, 15, v0
  v_lshl_add_u32 v248, v250, 7, v248
  s_lshl_b32 s29, s28, 13
  v_add_u32 v10, s29, v248
  v_xor_b32 v11, 64, v10
  v_add_u32 v12, 0x10000, v10
  v_add_u32 v13, 0x10000, v11
  v_mul_u32_u24 v248, 1536, v249
  v_bfe_u32 v250, v0, 2, 2
  v_lshl_add_u32 v248, v250, 6, v248
  v_and_b32 v250, 3, v0
  v_lshl_add_u32 v248, v250, 3, v248
  v_xor_b32 v249, s27, v249
  v_and_b32 v249, 1, v249
  v_lshl_add_u32 v248, v249, 5, v248
  v_add_u32 v14, 98304, v248
  v_and_b32 v248, 0x23, v0
  v_and_b32 v249, 12, v0
  v_lshl_or_b32 v248, v249, 1, v248
  v_and_b32 v249, 16, v0
  v_lshrrev_b32 v249, 2, v249
  v_or_b32 v248, v248, v249
  v_lshlrev_b32 v126, 4, v248
  v_lshrrev_b32 v249, 4, v0
  v_lshlrev_b32 v249, 9, v249
  v_and_b32 v250, 15, v0
  v_lshl_add_u32 v249, v250, 4, v249
  s_lshl_b32 s30, s27, 8
  s_lshl_b32 s31, s49, 11
  s_add_u32 s30, s30, s31
  v_add_u32 v127, s30, v249
  s_lshl_b32 s30, s49, 10
  s_add_u32 s55, s30, s48
  s_lshl_b32 s30, s27, 13
  s_lshl_b32 s31, s28, 11
  s_add_u32 s30, s30, s31
  s_add_u32 s30, s30, 131072
  v_add_u32 v128, s30, v126
  v_mov_b32 v236, 0xdddddddd
  v_lshlrev_b32 v237, 4, v0
  v_and_b32 v248, 27, v0
  v_cmp_eq_u32 vcc, 16, v248
  v_mov_b32 v249, 0x3f803f80
  v_mov_b32 v250, 0
  v_cndmask_b32 v220, v250, v249, vcc
  v_cndmask_b32 v221, v250, v249, vcc
  v_pk_mov_b32 v[222:223], v[220:221], v[220:221] op_sel:[0,1]
  v_pk_mov_b32 v[224:225], v[220:221], v[220:221] op_sel:[0,1]
  v_pk_mov_b32 v[226:227], v[220:221], v[220:221] op_sel:[0,1]
  v_pk_mov_b32 v[228:229], v[220:221], v[220:221] op_sel:[0,1]
  v_pk_mov_b32 v[230:231], v[220:221], v[220:221] op_sel:[0,1]
  v_pk_mov_b32 v[232:233], v[220:221], v[220:221] op_sel:[0,1]
  v_pk_mov_b32 v[234:235], v[220:221], v[220:221] op_sel:[0,1]
  v_mov_b32 v172, 0
  v_mov_b32 v173, 0
  v_pk_mov_b32 v[174:175], v[172:173], v[172:173] op_sel:[0,1]
  v_pk_mov_b32 v[176:177], v[172:173], v[172:173] op_sel:[0,1]
  v_pk_mov_b32 v[178:179], v[172:173], v[172:173] op_sel:[0,1]
  v_pk_mov_b32 v[180:181], v[172:173], v[172:173] op_sel:[0,1]
  v_pk_mov_b32 v[182:183], v[172:173], v[172:173] op_sel:[0,1]
  v_pk_mov_b32 v[184:185], v[172:173], v[172:173] op_sel:[0,1]
  v_pk_mov_b32 v[186:187], v[172:173], v[172:173] op_sel:[0,1]
  v_pk_mov_b32 v[188:189], v[172:173], v[172:173] op_sel:[0,1]
  v_pk_mov_b32 v[190:191], v[172:173], v[172:173] op_sel:[0,1]
  v_pk_mov_b32 v[192:193], v[172:173], v[172:173] op_sel:[0,1]
  v_pk_mov_b32 v[194:195], v[172:173], v[172:173] op_sel:[0,1]
  v_pk_mov_b32 v[196:197], v[172:173], v[172:173] op_sel:[0,1]
  v_pk_mov_b32 v[198:199], v[172:173], v[172:173] op_sel:[0,1]
  v_pk_mov_b32 v[200:201], v[172:173], v[172:173] op_sel:[0,1]
  v_pk_mov_b32 v[202:203], v[172:173], v[172:173] op_sel:[0,1]
  v_pk_mov_b32 v[164:165], v[172:173], v[172:173] op_sel:[0,1]
  v_pk_mov_b32 v[166:167], v[172:173], v[172:173] op_sel:[0,1]
  v_pk_mov_b32 v[168:169], v[172:173], v[172:173] op_sel:[0,1]
  v_pk_mov_b32 v[170:171], v[172:173], v[172:173] op_sel:[0,1]
  v_lshrrev_b32 v251, 5, v0
  v_and_b32 v249, 15, v0
  v_lshlrev_b32 v249, 4, v249
  v_lshl_add_u32 v248, v251, 9, v249
  s_lshl_b32 s29, s27, 8
  v_add_u32 v238, s29, v248
  s_lshl_b32 s29, s26, 14
  v_add_u32 v239, s29, v238
  s_lshl_b32 s29, s27, 13
  s_add_u32 s29, s29, 131072
  v_add_u32 v124, s29, v237
  v_and_b32 v240, 15, v0
  v_lshlrev_b32 v240, 7, v240
  v_lshl_add_u32 v242, v251, 8, v249
  v_and_b32 v248, 16, v0
  v_lshl_add_u32 v242, v248, 6, v242
  s_lshl_b32 s30, s24, 6
  s_add_u32 s30, s30, s49
  s_lshl_b32 s30, s30, 15
  s_lshl_b32 s29, s25, 11
  s_add_u32 s30, s30, s29
  s_lshl_b32 s29, s27, 9
  s_add_u32 s30, s30, s29
  s_add_u32 s4, s30, 8388608
  s_add_u32 s5, s4, 32768
  v_bfe_u32 v248, v0, 4, 1
  v_lshlrev_b32 v249, 1, v248
  v_xor_b32 v249, v249, v0
  v_and_b32 v249, 3, v249
  v_lshlrev_b32 v249, 4, v249
  v_lshrrev_b32 v250, 2, v0
  v_lshl_add_u32 v243, v250, 10, v249
  s_and_b32 s29, s25, 1
  s_lshl_b32 s29, s29, 9
  s_lshl_b32 s30, s3, 6
  s_add_u32 s7, s29, s30
  s_lshl_b32 s6, s3, 12
  s_add_u32 s6, s6, 131072
  v_lshlrev_b32 v249, 10, v251
  v_mul_u32_u24 v248, 288, v248
  v_add3_u32 v249, v249, v248, s6
  v_bfe_u32 v248, v0, 2, 2
  v_lshl_add_u32 v249, v248, 6, v249
  v_and_b32 v248, 3, v0
  v_lshl_add_u32 v244, v248, 3, v249
  v_xor_b32 v245, 32, v244
  s_lshl_b32 s54, s26, 13
  s_add_u32 s54, s54, 4096
  s_add_u32 s54, s54, 4096
  s_and_b32 s54, s54, 0xffff
  s_add_u32 s52, s54, s48
  s_lshl_b32 s53, s54, 1
  v_mov_b32 v125, 147456
  s_cmp_lg_u32 s3, 0
  s_cbranch_scc1 early_done
  ds_write_b32 v125, v172
early_done:
  v_mov_b32 v204, -1
  v_mov_b32 v205, -1
  v_mov_b32 v206, -1
  v_mov_b32 v207, -1
  s_waitcnt vmcnt(6)
  s_waitcnt lgkmcnt(0)
  s_barrier
  ds_read_b64_tr_b16 v[36:37], v14 offset:0
  ds_read_b64_tr_b16 v[38:39], v14 offset:768
  ds_read_b128 v[20:23], v10 offset:0
  ds_read_b64_tr_b16 v[40:41], v14 offset:256
  ds_read_b64_tr_b16 v[42:43], v14 offset:1024
  ds_read_b128 v[24:27], v10 offset:2048
  ds_read_b64_tr_b16 v[44:45], v14 offset:512
  ds_read_b64_tr_b16 v[46:47], v14 offset:1280
  ds_read_b128 v[28:31], v10 offset:4096
  ds_read_b128 v[32:35], v10 offset:6144
  s_waitcnt lgkmcnt(0)
  v_mfma_f32_16x16x32_bf16 v[76:79], v[36:39], v[20:23], 0
  ds_read_b64_tr_b16 v[64:65], v14 offset:6144
  ds_read_b64_tr_b16 v[66:67], v14 offset:6912
  v_mfma_f32_16x16x32_bf16 v[92:95], v[40:43], v[20:23], 0
  ds_read_b128 v[48:51], v11 offset:0
  ds_read_b64_tr_b16 v[68:69], v14 offset:6400
  v_mfma_f32_16x16x32_bf16 v[108:111], v[20:23], v[44:47], 0
  ds_read_b64_tr_b16 v[70:71], v14 offset:7168
  ds_read_b128 v[52:55], v11 offset:2048
  v_mfma_f32_16x16x32_bf16 v[80:83], v[36:39], v[24:27], 0
  ds_read_b64_tr_b16 v[72:73], v14 offset:6656
  ds_read_b64_tr_b16 v[74:75], v14 offset:7424
  v_mfma_f32_16x16x32_bf16 v[96:99], v[40:43], v[24:27], 0
  ds_read_b128 v[56:59], v11 offset:4096
  ds_read_b128 v[60:63], v11 offset:6144
  v_mfma_f32_16x16x32_bf16 v[112:115], v[24:27], v[44:47], 0
  s_add_u32 s41, s40, 2
  s_and_b32 s41, s41, 7
  s_add_u32 m0, s42, 65536
  s_lshl_b32 s44, s41, 7
  v_mfma_f32_16x16x32_bf16 v[84:87], v[36:39], v[28:31], 0
  buffer_load_dwordx4 v4, s[8:11], s44 offen offset:0 lds
  v_mfma_f32_16x16x32_bf16 v[100:103], v[40:43], v[28:31], 0
  buffer_load_dwordx4 v5, s[8:11], s44 offen offset:1024 lds
  v_mfma_f32_16x16x32_bf16 v[116:119], v[28:31], v[44:47], 0
  buffer_load_dwordx4 v6, s[8:11], s44 offen offset:2048 lds
  v_mfma_f32_16x16x32_bf16 v[88:91], v[36:39], v[32:35], 0
  buffer_load_dwordx4 v7, s[8:11], s44 offen offset:3072 lds
  v_mfma_f32_16x16x32_bf16 v[104:107], v[40:43], v[32:35], 0
  s_add_u32 s41, s40, 2
  s_and_b32 s41, s41, 7
  s_add_u32 m0, s43, 24576
  s_mul_i32 s45, s41, 196608
  buffer_load_dwordx4 v8, s[12:15], s45 offen lds
  v_mfma_f32_16x16x32_bf16 v[120:123], v[32:35], v[44:47], 0
  s_mov_b64 exec, s[46:47]
  buffer_load_dwordx4 v9, s[12:15], s45 offen offset:1024 lds
  s_mov_b64 exec, -1
  s_waitcnt lgkmcnt(0)
  v_mfma_f32_16x16x32_bf16 v[76:79], v[64:67], v[48:51], v[76:79]
  v_mfma_f32_16x16x32_bf16 v[92:95], v[68:71], v[48:51], v[92:95]
  v_mfma_f32_16x16x32_bf16 v[108:111], v[48:51], v[72:75], v[108:111]
  s_waitcnt vmcnt(6)
  s_barrier
  v_mfma_f32_16x16x32_bf16 v[80:83], v[64:67], v[52:55], v[80:83]
  ds_read_b64_tr_b16 v[36:37], v14 offset:12288
  ds_read_b64_tr_b16 v[38:39], v14 offset:13056
  v_mfma_f32_16x16x32_bf16 v[96:99], v[68:71], v[52:55], v[96:99]
  ds_read_b128 v[20:23], v10 offset:32768
  ds_read_b64_tr_b16 v[40:41], v14 offset:12544
  v_mfma_f32_16x16x32_bf16 v[112:115], v[52:55], v[72:75], v[112:115]
  ds_read_b64_tr_b16 v[42:43], v14 offset:13312
  ds_read_b128 v[24:27], v10 offset:34816
  v_mfma_f32_16x16x32_bf16 v[84:87], v[64:67], v[56:59], v[84:87]
  ds_read_b64_tr_b16 v[44:45], v14 offset:12800
  ds_read_b64_tr_b16 v[46:47], v14 offset:13568
  v_mfma_f32_16x16x32_bf16 v[100:103], v[68:71], v[56:59], v[100:103]
  ds_read_b128 v[28:31], v10 offset:36864
  ds_read_b128 v[32:35], v10 offset:38912
  v_mfma_f32_16x16x32_bf16 v[116:119], v[56:59], v[72:75], v[116:119]
  v_mfma_f32_16x16x32_bf16 v[88:91], v[64:67], v[60:63], v[88:91]
  v_mfma_f32_16x16x32_bf16 v[104:107], v[68:71], v[60:63], v[104:107]
  v_mfma_f32_16x16x32_bf16 v[120:123], v[60:63], v[72:75], v[120:123]
  s_waitcnt lgkmcnt(0)
  v_mfma_f32_16x16x32_bf16 v[76:79], v[36:39], v[20:23], v[76:79]
  ds_read_b64_tr_b16 v[64:65], v14 offset:18432
  ds_read_b64_tr_b16 v[66:67], v14 offset:19200
  v_mfma_f32_16x16x32_bf16 v[92:95], v[40:43], v[20:23], v[92:95]
  ds_read_b128 v[48:51], v11 offset:32768
  ds_read_b64_tr_b16 v[68:69], v14 offset:18688
  v_mfma_f32_16x16x32_bf16 v[108:111], v[20:23], v[44:47], v[108:111]
  ds_read_b64_tr_b16 v[70:71], v14 offset:19456
  ds_read_b128 v[52:55], v11 offset:34816
  v_mfma_f32_16x16x32_bf16 v[80:83], v[36:39], v[24:27], v[80:83]
  ds_read_b64_tr_b16 v[72:73], v14 offset:18944
  ds_read_b64_tr_b16 v[74:75], v14 offset:19712
  v_mfma_f32_16x16x32_bf16 v[96:99], v[40:43], v[24:27], v[96:99]
  ds_read_b128 v[56:59], v11 offset:36864
  ds_read_b128 v[60:63], v11 offset:38912
  v_mfma_f32_16x16x32_bf16 v[112:115], v[24:27], v[44:47], v[112:115]
  s_add_u32 s41, s40, 3
  s_and_b32 s41, s41, 7
  s_add_u32 m0, s42, 0
  s_lshl_b32 s44, s41, 7
  v_mfma_f32_16x16x32_bf16 v[84:87], v[36:39], v[28:31], v[84:87]
  buffer_load_dwordx4 v4, s[8:11], s44 offen offset:0 lds
  v_mfma_f32_16x16x32_bf16 v[100:103], v[40:43], v[28:31], v[100:103]
  buffer_load_dwordx4 v5, s[8:11], s44 offen offset:1024 lds
  v_mfma_f32_16x16x32_bf16 v[116:119], v[28:31], v[44:47], v[116:119]
  buffer_load_dwordx4 v6, s[8:11], s44 offen offset:2048 lds
  v_mfma_f32_16x16x32_bf16 v[88:91], v[36:39], v[32:35], v[88:91]
  buffer_load_dwordx4 v7, s[8:11], s44 offen offset:3072 lds
  v_mfma_f32_16x16x32_bf16 v[104:107], v[40:43], v[32:35], v[104:107]
  s_add_u32 s41, s40, 3
  s_and_b32 s41, s41, 7
  s_add_u32 m0, s43, 0
  s_mul_i32 s45, s41, 196608
  buffer_load_dwordx4 v8, s[12:15], s45 offen lds
  v_mfma_f32_16x16x32_bf16 v[120:123], v[32:35], v[44:47], v[120:123]
  s_mov_b64 exec, s[46:47]
  buffer_load_dwordx4 v9, s[12:15], s45 offen offset:1024 lds
  s_mov_b64 exec, -1
  s_waitcnt lgkmcnt(0)
  v_mfma_f32_16x16x32_bf16 v[76:79], v[64:67], v[48:51], v[76:79]
  v_mfma_f32_16x16x32_bf16 v[92:95], v[68:71], v[48:51], v[92:95]
  v_mfma_f32_16x16x32_bf16 v[108:111], v[48:51], v[72:75], v[108:111]
  s_waitcnt vmcnt(6)
  s_barrier
  v_mfma_f32_16x16x32_bf16 v[80:83], v[64:67], v[52:55], v[80:83]
  ds_read_b64_tr_b16 v[36:37], v14 offset:24576
  ds_read_b64_tr_b16 v[38:39], v14 offset:25344
  v_mfma_f32_16x16x32_bf16 v[96:99], v[68:71], v[52:55], v[96:99]
  ds_read_b128 v[20:23], v12 offset:0
  ds_read_b64_tr_b16 v[40:41], v14 offset:24832
  v_mfma_f32_16x16x32_bf16 v[112:115], v[52:55], v[72:75], v[112:115]
  ds_read_b64_tr_b16 v[42:43], v14 offset:25600
  ds_read_b128 v[24:27], v12 offset:2048
  v_mfma_f32_16x16x32_bf16 v[84:87], v[64:67], v[56:59], v[84:87]
  ds_read_b64_tr_b16 v[44:45], v14 offset:25088
  ds_read_b64_tr_b16 v[46:47], v14 offset:25856
  v_mfma_f32_16x16x32_bf16 v[100:103], v[68:71], v[56:59], v[100:103]
  ds_read_b128 v[28:31], v12 offset:4096
  ds_read_b128 v[32:35], v12 offset:6144
  v_mfma_f32_16x16x32_bf16 v[116:119], v[56:59], v[72:75], v[116:119]
  v_mfma_f32_16x16x32_bf16 v[88:91], v[64:67], v[60:63], v[88:91]
  v_mfma_f32_16x16x32_bf16 v[104:107], v[68:71], v[60:63], v[104:107]
  v_mfma_f32_16x16x32_bf16 v[120:123], v[60:63], v[72:75], v[120:123]
  s_waitcnt lgkmcnt(0)
  v_mfma_f32_16x16x32_bf16 v[76:79], v[36:39], v[20:23], v[76:79]
  ds_read_b64_tr_b16 v[64:65], v14 offset:30720
  ds_read_b64_tr_b16 v[66:67], v14 offset:31488
  v_mfma_f32_16x16x32_bf16 v[92:95], v[40:43], v[20:23], v[92:95]
  ds_read_b128 v[48:51], v13 offset:0
  ds_read_b64_tr_b16 v[68:69], v14 offset:30976
  v_mfma_f32_16x16x32_bf16 v[108:111], v[20:23], v[44:47], v[108:111]
  ds_read_b64_tr_b16 v[70:71], v14 offset:31744
  ds_read_b128 v[52:55], v13 offset:2048
  v_mfma_f32_16x16x32_bf16 v[80:83], v[36:39], v[24:27], v[80:83]
  ds_read_b64_tr_b16 v[72:73], v14 offset:31232
  ds_read_b64_tr_b16 v[74:75], v14 offset:32000
  v_mfma_f32_16x16x32_bf16 v[96:99], v[40:43], v[24:27], v[96:99]
  ds_read_b128 v[56:59], v13 offset:4096
  ds_read_b128 v[60:63], v13 offset:6144
  v_mfma_f32_16x16x32_bf16 v[112:115], v[24:27], v[44:47], v[112:115]
  s_add_u32 s41, s40, 4
  s_and_b32 s41, s41, 7
  s_add_u32 m0, s42, 32768
  s_lshl_b32 s44, s41, 7
  v_mfma_f32_16x16x32_bf16 v[84:87], v[36:39], v[28:31], v[84:87]
  buffer_load_dwordx4 v4, s[8:11], s44 offen offset:0 lds
  v_mfma_f32_16x16x32_bf16 v[100:103], v[40:43], v[28:31], v[100:103]
  buffer_load_dwordx4 v5, s[8:11], s44 offen offset:1024 lds
  v_mfma_f32_16x16x32_bf16 v[116:119], v[28:31], v[44:47], v[116:119]
  buffer_load_dwordx4 v6, s[8:11], s44 offen offset:2048 lds
  v_mfma_f32_16x16x32_bf16 v[88:91], v[36:39], v[32:35], v[88:91]
  buffer_load_dwordx4 v7, s[8:11], s44 offen offset:3072 lds
  v_mfma_f32_16x16x32_bf16 v[104:107], v[40:43], v[32:35], v[104:107]
  s_add_u32 s41, s40, 4
  s_and_b32 s41, s41, 7
  s_add_u32 m0, s43, 12288
  s_mul_i32 s45, s41, 196608
  buffer_load_dwordx4 v8, s[12:15], s45 offen lds
  v_mfma_f32_16x16x32_bf16 v[120:123], v[32:35], v[44:47], v[120:123]
  s_mov_b64 exec, s[46:47]
  buffer_load_dwordx4 v9, s[12:15], s45 offen offset:1024 lds
  s_mov_b64 exec, -1
  s_waitcnt lgkmcnt(0)
  v_mfma_f32_16x16x32_bf16 v[76:79], v[64:67], v[48:51], v[76:79]
  v_mfma_f32_16x16x32_bf16 v[92:95], v[68:71], v[48:51], v[92:95]
  v_mfma_f32_16x16x32_bf16 v[108:111], v[48:51], v[72:75], v[108:111]
  s_waitcnt vmcnt(6)
  s_barrier
  v_mfma_f32_16x16x32_bf16 v[80:83], v[64:67], v[52:55], v[80:83]
  ds_read_b64_tr_b16 v[36:37], v14 offset:0
  ds_read_b64_tr_b16 v[38:39], v14 offset:768
  v_mfma_f32_16x16x32_bf16 v[96:99], v[68:71], v[52:55], v[96:99]
  ds_read_b128 v[20:23], v10 offset:0
  ds_read_b64_tr_b16 v[40:41], v14 offset:256
  v_mfma_f32_16x16x32_bf16 v[112:115], v[52:55], v[72:75], v[112:115]
  ds_read_b64_tr_b16 v[42:43], v14 offset:1024
  ds_read_b128 v[24:27], v10 offset:2048
  v_mfma_f32_16x16x32_bf16 v[84:87], v[64:67], v[56:59], v[84:87]
  ds_read_b64_tr_b16 v[44:45], v14 offset:512
  ds_read_b64_tr_b16 v[46:47], v14 offset:1280
  v_mfma_f32_16x16x32_bf16 v[100:103], v[68:71], v[56:59], v[100:103]
  ds_read_b128 v[28:31], v10 offset:4096
  ds_read_b128 v[32:35], v10 offset:6144
  v_mfma_f32_16x16x32_bf16 v[116:119], v[56:59], v[72:75], v[116:119]
  v_mfma_f32_16x16x32_bf16 v[88:91], v[64:67], v[60:63], v[88:91]
  v_mfma_f32_16x16x32_bf16 v[104:107], v[68:71], v[60:63], v[104:107]
  v_mfma_f32_16x16x32_bf16 v[120:123], v[60:63], v[72:75], v[120:123]
  s_waitcnt lgkmcnt(0)
  v_mfma_f32_16x16x32_bf16 v[76:79], v[36:39], v[20:23], v[76:79]
  ds_read_b64_tr_b16 v[64:65], v14 offset:6144
  ds_read_b64_tr_b16 v[66:67], v14 offset:6912
  v_mfma_f32_16x16x32_bf16 v[92:95], v[40:43], v[20:23], v[92:95]
  ds_read_b128 v[48:51], v11 offset:0
  ds_read_b64_tr_b16 v[68:69], v14 offset:6400
  v_mfma_f32_16x16x32_bf16 v[108:111], v[20:23], v[44:47], v[108:111]
  ds_read_b64_tr_b16 v[70:71], v14 offset:7168
  ds_read_b128 v[52:55], v11 offset:2048
  v_mfma_f32_16x16x32_bf16 v[80:83], v[36:39], v[24:27], v[80:83]
  ds_read_b64_tr_b16 v[72:73], v14 offset:6656
  ds_read_b64_tr_b16 v[74:75], v14 offset:7424
  v_mfma_f32_16x16x32_bf16 v[96:99], v[40:43], v[24:27], v[96:99]
  ds_read_b128 v[56:59], v11 offset:4096
  ds_read_b128 v[60:63], v11 offset:6144
  v_mfma_f32_16x16x32_bf16 v[112:115], v[24:27], v[44:47], v[112:115]
  s_add_u32 s41, s40, 5
  s_and_b32 s41, s41, 7
  s_add_u32 m0, s42, 65536
  s_lshl_b32 s44, s41, 7
  v_mfma_f32_16x16x32_bf16 v[84:87], v[36:39], v[28:31], v[84:87]
  buffer_load_dwordx4 v4, s[8:11], s44 offen offset:0 lds
  v_mfma_f32_16x16x32_bf16 v[100:103], v[40:43], v[28:31], v[100:103]
  buffer_load_dwordx4 v5, s[8:11], s44 offen offset:1024 lds
  v_mfma_f32_16x16x32_bf16 v[116:119], v[28:31], v[44:47], v[116:119]
  buffer_load_dwordx4 v6, s[8:11], s44 offen offset:2048 lds
  v_mfma_f32_16x16x32_bf16 v[88:91], v[36:39], v[32:35], v[88:91]
  buffer_load_dwordx4 v7, s[8:11], s44 offen offset:3072 lds
  v_mfma_f32_16x16x32_bf16 v[104:107], v[40:43], v[32:35], v[104:107]
  s_add_u32 s41, s40, 5
  s_and_b32 s41, s41, 7
  s_add_u32 m0, s43, 24576
  s_mul_i32 s45, s41, 196608
  buffer_load_dwordx4 v8, s[12:15], s45 offen lds
  v_mfma_f32_16x16x32_bf16 v[120:123], v[32:35], v[44:47], v[120:123]
  s_mov_b64 exec, s[46:47]
  buffer_load_dwordx4 v9, s[12:15], s45 offen offset:1024 lds
  s_mov_b64 exec, -1
  s_waitcnt lgkmcnt(0)
  v_mfma_f32_16x16x32_bf16 v[76:79], v[64:67], v[48:51], v[76:79]
  v_mfma_f32_16x16x32_bf16 v[92:95], v[68:71], v[48:51], v[92:95]
  v_mfma_f32_16x16x32_bf16 v[108:111], v[48:51], v[72:75], v[108:111]
  s_waitcnt vmcnt(6)
  s_barrier
  v_mfma_f32_16x16x32_bf16 v[80:83], v[64:67], v[52:55], v[80:83]
  ds_read_b64_tr_b16 v[36:37], v14 offset:12288
  ds_read_b64_tr_b16 v[38:39], v14 offset:13056
  v_mfma_f32_16x16x32_bf16 v[96:99], v[68:71], v[52:55], v[96:99]
  ds_read_b128 v[20:23], v10 offset:32768
  ds_read_b64_tr_b16 v[40:41], v14 offset:12544
  v_mfma_f32_16x16x32_bf16 v[112:115], v[52:55], v[72:75], v[112:115]
  ds_read_b64_tr_b16 v[42:43], v14 offset:13312
  ds_read_b128 v[24:27], v10 offset:34816
  v_mfma_f32_16x16x32_bf16 v[84:87], v[64:67], v[56:59], v[84:87]
  ds_read_b64_tr_b16 v[44:45], v14 offset:12800
  ds_read_b64_tr_b16 v[46:47], v14 offset:13568
  v_mfma_f32_16x16x32_bf16 v[100:103], v[68:71], v[56:59], v[100:103]
  ds_read_b128 v[28:31], v10 offset:36864
  ds_read_b128 v[32:35], v10 offset:38912
  v_mfma_f32_16x16x32_bf16 v[116:119], v[56:59], v[72:75], v[116:119]
  v_mfma_f32_16x16x32_bf16 v[88:91], v[64:67], v[60:63], v[88:91]
  v_mfma_f32_16x16x32_bf16 v[104:107], v[68:71], v[60:63], v[104:107]
  v_mfma_f32_16x16x32_bf16 v[120:123], v[60:63], v[72:75], v[120:123]
  s_waitcnt lgkmcnt(0)
  v_mfma_f32_16x16x32_bf16 v[76:79], v[36:39], v[20:23], v[76:79]
  ds_read_b64_tr_b16 v[64:65], v14 offset:18432
  ds_read_b64_tr_b16 v[66:67], v14 offset:19200
  v_mfma_f32_16x16x32_bf16 v[92:95], v[40:43], v[20:23], v[92:95]
  ds_read_b128 v[48:51], v11 offset:32768
  ds_read_b64_tr_b16 v[68:69], v14 offset:18688
  v_mfma_f32_16x16x32_bf16 v[108:111], v[20:23], v[44:47], v[108:111]
  ds_read_b64_tr_b16 v[70:71], v14 offset:19456
  ds_read_b128 v[52:55], v11 offset:34816
  v_mfma_f32_16x16x32_bf16 v[80:83], v[36:39], v[24:27], v[80:83]
  ds_read_b64_tr_b16 v[72:73], v14 offset:18944
  ds_read_b64_tr_b16 v[74:75], v14 offset:19712
  v_mfma_f32_16x16x32_bf16 v[96:99], v[40:43], v[24:27], v[96:99]
  ds_read_b128 v[56:59], v11 offset:36864
  ds_read_b128 v[60:63], v11 offset:38912
  v_mfma_f32_16x16x32_bf16 v[112:115], v[24:27], v[44:47], v[112:115]
  s_add_u32 s41, s40, 6
  s_and_b32 s41, s41, 7
  s_add_u32 m0, s42, 0
  s_lshl_b32 s44, s41, 7
  v_mfma_f32_16x16x32_bf16 v[84:87], v[36:39], v[28:31], v[84:87]
  buffer_load_dwordx4 v4, s[8:11], s44 offen offset:0 lds
  v_mfma_f32_16x16x32_bf16 v[100:103], v[40:43], v[28:31], v[100:103]
  buffer_load_dwordx4 v5, s[8:11], s44 offen offset:1024 lds
  v_mfma_f32_16x16x32_bf16 v[116:119], v[28:31], v[44:47], v[116:119]
  buffer_load_dwordx4 v6, s[8:11], s44 offen offset:2048 lds
  v_mfma_f32_16x16x32_bf16 v[88:91], v[36:39], v[32:35], v[88:91]
  buffer_load_dwordx4 v7, s[8:11], s44 offen offset:3072 lds
  v_mfma_f32_16x16x32_bf16 v[104:107], v[40:43], v[32:35], v[104:107]
  s_add_u32 s41, s40, 6
  s_and_b32 s41, s41, 7
  s_add_u32 m0, s43, 0
  s_mul_i32 s45, s41, 196608
  buffer_load_dwordx4 v8, s[12:15], s45 offen lds
  v_mfma_f32_16x16x32_bf16 v[120:123], v[32:35], v[44:47], v[120:123]
  s_mov_b64 exec, s[46:47]
  buffer_load_dwordx4 v9, s[12:15], s45 offen offset:1024 lds
  s_mov_b64 exec, -1
  s_waitcnt lgkmcnt(0)
  v_mfma_f32_16x16x32_bf16 v[76:79], v[64:67], v[48:51], v[76:79]
  v_mfma_f32_16x16x32_bf16 v[92:95], v[68:71], v[48:51], v[92:95]
  v_mfma_f32_16x16x32_bf16 v[108:111], v[48:51], v[72:75], v[108:111]
  s_waitcnt vmcnt(6)
  s_barrier
  v_mfma_f32_16x16x32_bf16 v[80:83], v[64:67], v[52:55], v[80:83]
  ds_read_b64_tr_b16 v[36:37], v14 offset:24576
  ds_read_b64_tr_b16 v[38:39], v14 offset:25344
  v_mfma_f32_16x16x32_bf16 v[96:99], v[68:71], v[52:55], v[96:99]
  ds_read_b128 v[20:23], v12 offset:0
  ds_read_b64_tr_b16 v[40:41], v14 offset:24832
  v_mfma_f32_16x16x32_bf16 v[112:115], v[52:55], v[72:75], v[112:115]
  ds_read_b64_tr_b16 v[42:43], v14 offset:25600
  ds_read_b128 v[24:27], v12 offset:2048
  v_mfma_f32_16x16x32_bf16 v[84:87], v[64:67], v[56:59], v[84:87]
  ds_read_b64_tr_b16 v[44:45], v14 offset:25088
  ds_read_b64_tr_b16 v[46:47], v14 offset:25856
  v_mfma_f32_16x16x32_bf16 v[100:103], v[68:71], v[56:59], v[100:103]
  ds_read_b128 v[28:31], v12 offset:4096
  ds_read_b128 v[32:35], v12 offset:6144
  v_mfma_f32_16x16x32_bf16 v[116:119], v[56:59], v[72:75], v[116:119]
  v_mfma_f32_16x16x32_bf16 v[88:91], v[64:67], v[60:63], v[88:91]
  v_mfma_f32_16x16x32_bf16 v[104:107], v[68:71], v[60:63], v[104:107]
  v_mfma_f32_16x16x32_bf16 v[120:123], v[60:63], v[72:75], v[120:123]
  s_waitcnt lgkmcnt(0)
  v_mfma_f32_16x16x32_bf16 v[76:79], v[36:39], v[20:23], v[76:79]
  ds_read_b64_tr_b16 v[64:65], v14 offset:30720
  ds_read_b64_tr_b16 v[66:67], v14 offset:31488
  v_mfma_f32_16x16x32_bf16 v[92:95], v[40:43], v[20:23], v[92:95]
  ds_read_b128 v[48:51], v13 offset:0
  ds_read_b64_tr_b16 v[68:69], v14 offset:30976
  v_mfma_f32_16x16x32_bf16 v[108:111], v[20:23], v[44:47], v[108:111]
  ds_read_b64_tr_b16 v[70:71], v14 offset:31744
  ds_read_b128 v[52:55], v13 offset:2048
  v_mfma_f32_16x16x32_bf16 v[80:83], v[36:39], v[24:27], v[80:83]
  ds_read_b64_tr_b16 v[72:73], v14 offset:31232
  ds_read_b64_tr_b16 v[74:75], v14 offset:32000
  v_mfma_f32_16x16x32_bf16 v[96:99], v[40:43], v[24:27], v[96:99]
  ds_read_b128 v[56:59], v13 offset:4096
  ds_read_b128 v[60:63], v13 offset:6144
  v_mfma_f32_16x16x32_bf16 v[112:115], v[24:27], v[44:47], v[112:115]
  s_add_u32 s41, s40, 7
  s_and_b32 s41, s41, 7
  s_add_u32 m0, s42, 32768
  s_lshl_b32 s44, s41, 7
  v_mfma_f32_16x16x32_bf16 v[84:87], v[36:39], v[28:31], v[84:87]
  buffer_load_dwordx4 v4, s[8:11], s44 offen offset:0 lds
  v_mfma_f32_16x16x32_bf16 v[100:103], v[40:43], v[28:31], v[100:103]
  buffer_load_dwordx4 v5, s[8:11], s44 offen offset:1024 lds
  v_mfma_f32_16x16x32_bf16 v[116:119], v[28:31], v[44:47], v[116:119]
  buffer_load_dwordx4 v6, s[8:11], s44 offen offset:2048 lds
  v_mfma_f32_16x16x32_bf16 v[88:91], v[36:39], v[32:35], v[88:91]
  buffer_load_dwordx4 v7, s[8:11], s44 offen offset:3072 lds
  v_mfma_f32_16x16x32_bf16 v[104:107], v[40:43], v[32:35], v[104:107]
  s_add_u32 s41, s40, 7
  s_and_b32 s41, s41, 7
  s_add_u32 m0, s43, 12288
  s_mul_i32 s45, s41, 196608
  buffer_load_dwordx4 v8, s[12:15], s45 offen lds
  v_mfma_f32_16x16x32_bf16 v[120:123], v[32:35], v[44:47], v[120:123]
  s_mov_b64 exec, s[46:47]
  buffer_load_dwordx4 v9, s[12:15], s45 offen offset:1024 lds
  s_mov_b64 exec, -1
  s_waitcnt lgkmcnt(0)
  v_mfma_f32_16x16x32_bf16 v[76:79], v[64:67], v[48:51], v[76:79]
  v_mfma_f32_16x16x32_bf16 v[92:95], v[68:71], v[48:51], v[92:95]
  v_mfma_f32_16x16x32_bf16 v[108:111], v[48:51], v[72:75], v[108:111]
  s_waitcnt vmcnt(6)
  s_barrier
  v_mfma_f32_16x16x32_bf16 v[80:83], v[64:67], v[52:55], v[80:83]
  ds_read_b64_tr_b16 v[36:37], v14 offset:0
  ds_read_b64_tr_b16 v[38:39], v14 offset:768
  v_mfma_f32_16x16x32_bf16 v[96:99], v[68:71], v[52:55], v[96:99]
  ds_read_b128 v[20:23], v10 offset:0
  ds_read_b64_tr_b16 v[40:41], v14 offset:256
  v_mfma_f32_16x16x32_bf16 v[112:115], v[52:55], v[72:75], v[112:115]
  ds_read_b64_tr_b16 v[42:43], v14 offset:1024
  ds_read_b128 v[24:27], v10 offset:2048
  v_mfma_f32_16x16x32_bf16 v[84:87], v[64:67], v[56:59], v[84:87]
  ds_read_b64_tr_b16 v[44:45], v14 offset:512
  ds_read_b64_tr_b16 v[46:47], v14 offset:1280
  v_mfma_f32_16x16x32_bf16 v[100:103], v[68:71], v[56:59], v[100:103]
  ds_read_b128 v[28:31], v10 offset:4096
  ds_read_b128 v[32:35], v10 offset:6144
  v_mfma_f32_16x16x32_bf16 v[116:119], v[56:59], v[72:75], v[116:119]
  v_mfma_f32_16x16x32_bf16 v[88:91], v[64:67], v[60:63], v[88:91]
  v_mfma_f32_16x16x32_bf16 v[104:107], v[68:71], v[60:63], v[104:107]
  v_mfma_f32_16x16x32_bf16 v[120:123], v[60:63], v[72:75], v[120:123]
  s_waitcnt lgkmcnt(0)
  v_mfma_f32_16x16x32_bf16 v[76:79], v[36:39], v[20:23], v[76:79]
  ds_read_b64_tr_b16 v[64:65], v14 offset:6144
  ds_read_b64_tr_b16 v[66:67], v14 offset:6912
  v_mfma_f32_16x16x32_bf16 v[92:95], v[40:43], v[20:23], v[92:95]
  ds_read_b128 v[48:51], v11 offset:0
  ds_read_b64_tr_b16 v[68:69], v14 offset:6400
  v_mfma_f32_16x16x32_bf16 v[108:111], v[20:23], v[44:47], v[108:111]
  ds_read_b64_tr_b16 v[70:71], v14 offset:7168
  ds_read_b128 v[52:55], v11 offset:2048
  v_mfma_f32_16x16x32_bf16 v[80:83], v[36:39], v[24:27], v[80:83]
  ds_read_b64_tr_b16 v[72:73], v14 offset:6656
  ds_read_b64_tr_b16 v[74:75], v14 offset:7424
  v_mfma_f32_16x16x32_bf16 v[96:99], v[40:43], v[24:27], v[96:99]
  ds_read_b128 v[56:59], v11 offset:4096
  ds_read_b128 v[60:63], v11 offset:6144
  v_mfma_f32_16x16x32_bf16 v[112:115], v[24:27], v[44:47], v[112:115]
  buffer_store_dwordx4 v[204:207], v242, s[16:19], s4 offen sc1
  v_mfma_f32_16x16x32_bf16 v[84:87], v[36:39], v[28:31], v[84:87]
  buffer_store_dwordx4 v[204:207], v242, s[16:19], s5 offen sc1
  v_mfma_f32_16x16x32_bf16 v[100:103], v[40:43], v[28:31], v[100:103]
  v_mfma_f32_16x16x32_bf16 v[116:119], v[28:31], v[44:47], v[116:119]
  v_mfma_f32_16x16x32_bf16 v[88:91], v[36:39], v[32:35], v[88:91]
  v_mfma_f32_16x16x32_bf16 v[104:107], v[40:43], v[32:35], v[104:107]
  v_mfma_f32_16x16x32_bf16 v[120:123], v[32:35], v[44:47], v[120:123]
  s_waitcnt lgkmcnt(0)
  v_mfma_f32_16x16x32_bf16 v[76:79], v[64:67], v[48:51], v[76:79]
  v_mfma_f32_16x16x32_bf16 v[92:95], v[68:71], v[48:51], v[92:95]
  v_mfma_f32_16x16x32_bf16 v[108:111], v[48:51], v[72:75], v[108:111]
  s_waitcnt vmcnt(2)
  s_barrier
  v_mfma_f32_16x16x32_bf16 v[80:83], v[64:67], v[52:55], v[80:83]
  ds_read_b64_tr_b16 v[36:37], v14 offset:12288
  ds_read_b64_tr_b16 v[38:39], v14 offset:13056
  v_mfma_f32_16x16x32_bf16 v[96:99], v[68:71], v[52:55], v[96:99]
  ds_read_b128 v[20:23], v10 offset:32768
  ds_read_b64_tr_b16 v[40:41], v14 offset:12544
  v_mfma_f32_16x16x32_bf16 v[112:115], v[52:55], v[72:75], v[112:115]
  ds_read_b64_tr_b16 v[42:43], v14 offset:13312
  ds_read_b128 v[24:27], v10 offset:34816
  v_mfma_f32_16x16x32_bf16 v[84:87], v[64:67], v[56:59], v[84:87]
  ds_read_b64_tr_b16 v[44:45], v14 offset:12800
  ds_read_b64_tr_b16 v[46:47], v14 offset:13568
  v_mfma_f32_16x16x32_bf16 v[100:103], v[68:71], v[56:59], v[100:103]
  ds_read_b128 v[28:31], v10 offset:36864
  ds_read_b128 v[32:35], v10 offset:38912
  v_mfma_f32_16x16x32_bf16 v[116:119], v[56:59], v[72:75], v[116:119]
  v_mfma_f32_16x16x32_bf16 v[88:91], v[64:67], v[60:63], v[88:91]
  v_mfma_f32_16x16x32_bf16 v[104:107], v[68:71], v[60:63], v[104:107]
  v_mfma_f32_16x16x32_bf16 v[120:123], v[60:63], v[72:75], v[120:123]
  s_waitcnt lgkmcnt(0)
  v_mfma_f32_16x16x32_bf16 v[76:79], v[36:39], v[20:23], v[76:79]
  ds_read_b64_tr_b16 v[64:65], v14 offset:18432
  ds_read_b64_tr_b16 v[66:67], v14 offset:19200
  v_mfma_f32_16x16x32_bf16 v[92:95], v[40:43], v[20:23], v[92:95]
  ds_read_b128 v[48:51], v11 offset:32768
  ds_read_b64_tr_b16 v[68:69], v14 offset:18688
  v_mfma_f32_16x16x32_bf16 v[108:111], v[20:23], v[44:47], v[108:111]
  ds_read_b64_tr_b16 v[70:71], v14 offset:19456
  ds_read_b128 v[52:55], v11 offset:34816
  v_mfma_f32_16x16x32_bf16 v[80:83], v[36:39], v[24:27], v[80:83]
  ds_read_b64_tr_b16 v[72:73], v14 offset:18944
  ds_read_b64_tr_b16 v[74:75], v14 offset:19712
  v_mfma_f32_16x16x32_bf16 v[96:99], v[40:43], v[24:27], v[96:99]
  ds_read_b128 v[56:59], v11 offset:36864
  ds_read_b128 v[60:63], v11 offset:38912
  v_mfma_f32_16x16x32_bf16 v[112:115], v[24:27], v[44:47], v[112:115]
  v_mfma_f32_16x16x32_bf16 v[84:87], v[36:39], v[28:31], v[84:87]
  v_mfma_f32_16x16x32_bf16 v[100:103], v[40:43], v[28:31], v[100:103]
  v_mfma_f32_16x16x32_bf16 v[116:119], v[28:31], v[44:47], v[116:119]
  v_mfma_f32_16x16x32_bf16 v[88:91], v[36:39], v[32:35], v[88:91]
  v_mfma_f32_16x16x32_bf16 v[104:107], v[40:43], v[32:35], v[104:107]
  v_mfma_f32_16x16x32_bf16 v[120:123], v[32:35], v[44:47], v[120:123]
  s_waitcnt lgkmcnt(0)
  s_barrier
  v_mfma_f32_16x16x32_bf16 v[108:111], v[48:51], v[72:75], v[108:111]
  v_mfma_f32_16x16x32_bf16 v[112:115], v[52:55], v[72:75], v[112:115]
  v_mfma_f32_16x16x32_bf16 v[116:119], v[56:59], v[72:75], v[116:119]
  v_mfma_f32_16x16x32_bf16 v[120:123], v[60:63], v[72:75], v[120:123]
  v_mfma_f32_16x16x32_bf16 v[92:95], v[68:71], v[48:51], v[92:95]
  v_mfma_f32_16x16x32_bf16 v[96:99], v[68:71], v[52:55], v[96:99]
  v_mfma_f32_16x16x32_bf16 v[100:103], v[68:71], v[56:59], v[100:103]
  v_mfma_f32_16x16x32_bf16 v[104:107], v[68:71], v[60:63], v[104:107]
  v_mfma_f32_16x16x32_bf16 v[76:79], v[64:67], v[48:51], v[76:79]
  v_mfma_f32_16x16x32_bf16 v[80:83], v[64:67], v[52:55], v[80:83]
  v_mfma_f32_16x16x32_bf16 v[84:87], v[64:67], v[56:59], v[84:87]
  v_mfma_f32_16x16x32_bf16 v[88:91], v[64:67], v[60:63], v[88:91]
  s_mov_b32 s29, 0x3eb8aa3b
  s_mul_i32 s51, s51, 1664525
  s_add_u32 s51, s51, 1013904223
  s_mul_i32 s39, s39, 1664525
  s_add_u32 s39, s39, 1013904223
  s_getreg_b32 s101, hwreg(HW_REG_XCC_ID, 0, 4)
  s_mov_b32 s46, 0xffff
  s_mov_b32 s47, 0xffff
  s_mov_b32 s12, s32
  s_mov_b32 s13, s33
  s_mov_b32 s14, 524288
  s_mov_b32 s15, 0x20000
  v_cvt_pk_bf16_f32 v28, v108, v109
  v_cvt_pk_bf16_f32 v29, v110, v111
  v_cvt_pk_bf16_f32 v30, v112, v113
  v_cvt_pk_bf16_f32 v31, v114, v115
  v_cvt_pk_bf16_f32 v32, v116, v117
  v_cvt_pk_bf16_f32 v33, v118, v119
  v_cvt_pk_bf16_f32 v34, v120, v121
  v_cvt_pk_bf16_f32 v35, v122, v123
  buffer_store_dwordx4 v[28:31], v127, s[16:19], s57 offen offset:0 sc1
  buffer_store_dwordx4 v[32:35], v127, s[16:19], s57 offen offset:2048 sc1
  v_cvt_pk_bf16_f32 v20, v92, v93
  v_cvt_pk_bf16_f32 v21, v94, v95
  v_cvt_pk_bf16_f32 v22, v96, v97
  v_cvt_pk_bf16_f32 v23, v98, v99
  v_cvt_pk_bf16_f32 v24, v100, v101
  v_cvt_pk_bf16_f32 v25, v102, v103
  v_cvt_pk_bf16_f32 v26, v104, v105
  v_cvt_pk_bf16_f32 v27, v106, v107
  ds_write_b128 v127, v[28:31] offset:0
  ds_write_b128 v127, v[32:35] offset:2048
  v_permlane16_swap_b32 v20, v22
  v_permlane16_swap_b32 v21, v23
  v_permlane16_swap_b32 v24, v26
  v_permlane16_swap_b32 v25, v27
  ds_write_b128 v128, v[20:23] offset:0
  ds_write_b128 v128, v[24:27] offset:1024
  buffer_store_dwordx4 v[20:23], v126, s[16:19], s55 offen offset:0 sc1
  buffer_store_dwordx4 v[24:27], v126, s[16:19], s55 offen offset:1024 sc1
  v_mul_f32 v76, s29, v76
  v_mul_f32 v77, s29, v77
  v_mul_f32 v78, s29, v78
  v_mul_f32 v79, s29, v79
  v_mul_f32 v80, s29, v80
  v_mul_f32 v81, s29, v81
  v_mul_f32 v82, s29, v82
  v_mul_f32 v83, s29, v83
  v_mul_f32 v84, s29, v84
  v_mul_f32 v85, s29, v85
  v_mul_f32 v86, s29, v86
  v_mul_f32 v87, s29, v87
  v_mul_f32 v88, s29, v88
  v_mul_f32 v89, s29, v89
  v_mul_f32 v90, s29, v90
  v_mul_f32 v91, s29, v91
  v_cvt_pk_bf16_f32 v132, v76, v77
  v_cvt_pk_bf16_f32 v133, v78, v79
  v_cvt_pk_bf16_f32 v134, v80, v81
  v_cvt_pk_bf16_f32 v135, v82, v83
  v_cvt_pk_bf16_f32 v136, v84, v85
  v_cvt_pk_bf16_f32 v137, v86, v87
  v_cvt_pk_bf16_f32 v138, v88, v89
  v_cvt_pk_bf16_f32 v139, v90, v91
  v_mov_b32 v241, s51
  s_nop 0
  v_permlane16_swap_b32 v132, v134
  v_permlane16_swap_b32 v133, v135
  v_permlane16_swap_b32 v136, v138
  v_permlane16_swap_b32 v137, v139
  s_waitcnt lgkmcnt(0)
  s_barrier
  ds_read_b128 v[4:7], v124
  s_mov_b64 exec, s[46:47]
  ds_read_b128 v[220:223], v239 offset:0
  ds_read_b128 v[224:227], v239 offset:1024
  s_mov_b64 exec, -1
  s_waitcnt lgkmcnt(2)
  v_mfma_f32_32x32x16_bf16 v[140:155], v[4:7], v[132:135], 4.0
  s_nop 7
  s_nop 3
  s_cmp_lg_u32 s27, 1
  s_cbranch_scc1 own_skip0_1
  v_mov_b32 v250, 1
  s_waitcnt vmcnt(0)
  s_mov_b64 exec, 1
  ds_add_rtn_u32 v250, v125, v250
  s_lshl_b32 s29, s26, 7
  v_mov_b32 v251, s29
  s_lshl_b32 s29, s25, 7
  v_mov_b32 v253, s29
  v_mov_b32 v254, s39
  s_xor_b32 s29, s39, s101
  v_mov_b32 v255, s29
  s_waitcnt lgkmcnt(0)
  v_cmp_eq_u32 vcc, 7, v250
  s_and_saveexec_b64 s[58:59], vcc
  s_cbranch_execz own_notlast1
  buffer_store_dword v241, v251, s[16:19], s50 offen sc1
  buffer_store_dwordx2 v[254:255], v253, s[16:19], s38 offen sc1
own_notlast1:
  s_mov_b64 exec, -1
  s_setprio 1
own_skip0_1:
  v_exp_f32 v140, v140
  v_exp_f32 v141, v141
  v_smfmac_f32_32x32x32_bf16 v[188:203], v[232:235], v[164:171], v236
  v_exp_f32 v142, v142
  v_exp_f32 v143, v143
  v_exp_f32 v144, v144
  v_mfma_f32_32x32x16_bf16 v[156:171], v[4:7], v[136:139], 4.0
  v_exp_f32 v145, v145
  v_exp_f32 v146, v146
  v_exp_f32 v147, v147
  ds_read_b128 v[8:11], v124 offset:1024
  s_mov_b64 exec, s[46:47]
  ds_read_b128 v[228:231], v239 offset:2048
  ds_read_b128 v[232:235], v239 offset:3072
  s_mov_b64 exec, -1
  v_exp_f32 v148, v148
  v_exp_f32 v149, v149
  s_waitcnt lgkmcnt(3)
  v_smfmac_f32_32x32x32_bf16 v[172:187], v[220:223], v[140:147], v236
  v_exp_f32 v150, v150
  v_exp_f32 v151, v151
  v_exp_f32 v152, v152
  v_exp_f32 v153, v153
  v_exp_f32 v154, v154
  v_exp_f32 v155, v155
  v_exp_f32 v156, v156
  v_exp_f32 v157, v157
  v_smfmac_f32_32x32x32_bf16 v[172:187], v[224:227], v[148:155], v236
  v_exp_f32 v158, v158
  v_exp_f32 v159, v159
  v_exp_f32 v160, v160
  s_waitcnt lgkmcnt(0)
  v_mfma_f32_32x32x16_bf16 v[140:155], v[8:11], v[132:135], 4.0
  v_exp_f32 v161, v161
  v_exp_f32 v162, v162
  v_exp_f32 v163, v163
  v_exp_f32 v164, v164
  v_exp_f32 v165, v165
  v_smfmac_f32_32x32x32_bf16 v[188:203], v[220:223], v[156:163], v236
  v_exp_f32 v166, v166
  v_exp_f32 v167, v167
  v_exp_f32 v168, v168
  v_exp_f32 v169, v169
  v_exp_f32 v170, v170
  v_exp_f32 v171, v171
  v_exp_f32 v140, v140
  v_exp_f32 v141, v141
  v_smfmac_f32_32x32x32_bf16 v[188:203], v[224:227], v[164:171], v236
  v_exp_f32 v142, v142
  v_exp_f32 v143, v143
  v_exp_f32 v144, v144
  v_mfma_f32_32x32x16_bf16 v[156:171], v[8:11], v[136:139], 4.0
  v_exp_f32 v145, v145
  v_exp_f32 v146, v146
  v_exp_f32 v147, v147
  ds_read_b128 v[4:7], v124 offset:2048
  s_mov_b64 exec, s[46:47]
  ds_read_b128 v[220:223], v239 offset:4096
  ds_read_b128 v[224:227], v239 offset:5120
  s_mov_b64 exec, -1
  v_exp_f32 v148, v148
  v_exp_f32 v149, v149
  v_smfmac_f32_32x32x32_bf16 v[172:187], v[228:231], v[140:147], v236
  v_exp_f32 v150, v150
  v_exp_f32 v151, v151
  v_exp_f32 v152, v152
  v_exp_f32 v153, v153
  v_exp_f32 v154, v154
  v_exp_f32 v155, v155
  v_exp_f32 v156, v156
  v_exp_f32 v157, v157
  v_smfmac_f32_32x32x32_bf16 v[172:187], v[232:235], v[148:155], v236
  v_exp_f32 v158, v158
  v_exp_f32 v159, v159
  v_exp_f32 v160, v160
  s_waitcnt lgkmcnt(0)
  v_mfma_f32_32x32x16_bf16 v[140:155], v[4:7], v[132:135], 4.0
  v_exp_f32 v161, v161
  v_exp_f32 v162, v162
  v_exp_f32 v163, v163
  v_exp_f32 v164, v164
  v_exp_f32 v165, v165
  v_smfmac_f32_32x32x32_bf16 v[188:203], v[228:231], v[156:163], v236
  v_exp_f32 v166, v166
  v_exp_f32 v167, v167
  v_exp_f32 v168, v168
  v_exp_f32 v169, v169
  v_exp_f32 v170, v170
  v_exp_f32 v171, v171
  s_cmp_lg_u32 s27, 0
  s_cbranch_scc1 own_skip2_0
  v_mov_b32 v250, 1
  s_waitcnt vmcnt(0)
  s_mov_b64 exec, 1
  ds_add_rtn_u32 v250, v125, v250
  s_lshl_b32 s29, s26, 7
  v_mov_b32 v251, s29
  s_lshl_b32 s29, s25, 7
  v_mov_b32 v253, s29
  v_mov_b32 v254, s39
  s_xor_b32 s29, s39, s101
  v_mov_b32 v255, s29
  s_waitcnt lgkmcnt(0)
  v_cmp_eq_u32 vcc, 7, v250
  s_and_saveexec_b64 s[58:59], vcc
  s_cbranch_execz own_notlast0
  buffer_store_dword v241, v251, s[16:19], s50 offen sc1
  buffer_store_dwordx2 v[254:255], v253, s[16:19], s38 offen sc1
own_notlast0:
  s_mov_b64 exec, -1
own_skip2_0:
  v_exp_f32 v140, v140
  v_exp_f32 v141, v141
  v_smfmac_f32_32x32x32_bf16 v[188:203], v[232:235], v[164:171], v236
  v_exp_f32 v142, v142
  v_exp_f32 v143, v143
  v_exp_f32 v144, v144
  v_mfma_f32_32x32x16_bf16 v[156:171], v[4:7], v[136:139], 4.0
  v_exp_f32 v145, v145
  v_exp_f32 v146, v146
  v_exp_f32 v147, v147
  ds_read_b128 v[8:11], v124 offset:3072
  s_mov_b64 exec, s[46:47]
  ds_read_b128 v[228:231], v239 offset:6144
  ds_read_b128 v[232:235], v239 offset:7168
  s_mov_b64 exec, -1
  v_exp_f32 v148, v148
  v_exp_f32 v149, v149
  v_smfmac_f32_32x32x32_bf16 v[172:187], v[220:223], v[140:147], v236
  v_exp_f32 v150, v150
  v_exp_f32 v151, v151
  v_exp_f32 v152, v152
  v_exp_f32 v153, v153
  v_exp_f32 v154, v154
  v_exp_f32 v155, v155
  v_exp_f32 v156, v156
  v_exp_f32 v157, v157
  v_smfmac_f32_32x32x32_bf16 v[172:187], v[224:227], v[148:155], v236
  v_exp_f32 v158, v158
  v_exp_f32 v159, v159
  v_exp_f32 v160, v160
  s_waitcnt lgkmcnt(0)
  v_mfma_f32_32x32x16_bf16 v[140:155], v[8:11], v[132:135], 4.0
  v_exp_f32 v161, v161
  v_exp_f32 v162, v162
  v_exp_f32 v163, v163
  v_exp_f32 v164, v164
  v_exp_f32 v165, v165
  v_smfmac_f32_32x32x32_bf16 v[188:203], v[220:223], v[156:163], v236
  v_exp_f32 v166, v166
  v_exp_f32 v167, v167
  v_exp_f32 v168, v168
  v_exp_f32 v169, v169
  v_exp_f32 v170, v170
  v_exp_f32 v171, v171
  v_exp_f32 v140, v140
  v_exp_f32 v141, v141
  v_smfmac_f32_32x32x32_bf16 v[188:203], v[224:227], v[164:171], v236
  v_exp_f32 v142, v142
  v_exp_f32 v143, v143
  v_exp_f32 v144, v144
  v_mfma_f32_32x32x16_bf16 v[156:171], v[8:11], v[136:139], 4.0
  v_exp_f32 v145, v145
  v_exp_f32 v146, v146
  v_exp_f32 v147, v147
  ds_read_b128 v[4:7], v124 offset:4096
  s_mov_b64 exec, s[46:47]
  ds_read_b128 v[220:223], v239 offset:8192
  ds_read_b128 v[224:227], v239 offset:9216
  s_mov_b64 exec, -1
  v_exp_f32 v148, v148
  v_exp_f32 v149, v149
  v_smfmac_f32_32x32x32_bf16 v[172:187], v[228:231], v[140:147], v236
  v_exp_f32 v150, v150
  v_exp_f32 v151, v151
  v_exp_f32 v152, v152
  v_exp_f32 v153, v153
  v_exp_f32 v154, v154
  v_exp_f32 v155, v155
  v_exp_f32 v156, v156
  v_exp_f32 v157, v157
  v_smfmac_f32_32x32x32_bf16 v[172:187], v[232:235], v[148:155], v236
  v_exp_f32 v158, v158
  v_exp_f32 v159, v159
  v_exp_f32 v160, v160
  s_waitcnt lgkmcnt(0)
  v_mfma_f32_32x32x16_bf16 v[140:155], v[4:7], v[132:135], 4.0
  v_exp_f32 v161, v161
  v_exp_f32 v162, v162
  v_exp_f32 v163, v163
  v_exp_f32 v164, v164
  v_exp_f32 v165, v165
  v_smfmac_f32_32x32x32_bf16 v[188:203], v[228:231], v[156:163], v236
  v_exp_f32 v166, v166
  v_exp_f32 v167, v167
  v_exp_f32 v168, v168
  v_exp_f32 v169, v169
  v_exp_f32 v170, v170
  v_exp_f32 v171, v171
  s_cmp_lg_u32 s27, 0
  s_cbranch_scc1 own_skip4_0
  s_add_u32 s29, s26, 1
  s_and_b32 s29, s29, 7
  s_lshl_b32 s29, s29, 7
  v_mov_b32 v249, s29
  buffer_load_dword v248, v249, s[16:19], s50 offen sc1
own_skip4_0:
  s_cmp_lg_u32 s27, 1
  s_cbranch_scc1 own_skip4_1
  s_add_u32 s29, s26, 1
  s_and_b32 s29, s29, 7
  s_lshl_b32 s29, s29, 7
  v_mov_b32 v249, s29
  buffer_load_dword v248, v249, s[16:19], s50 offen sc1
own_skip4_1:
  v_exp_f32 v140, v140
  v_exp_f32 v141, v141
  v_smfmac_f32_32x32x32_bf16 v[188:203], v[232:235], v[164:171], v236
  v_exp_f32 v142, v142
  v_exp_f32 v143, v143
  v_exp_f32 v144, v144
  v_mfma_f32_32x32x16_bf16 v[156:171], v[4:7], v[136:139], 4.0
  v_exp_f32 v145, v145
  v_exp_f32 v146, v146
  v_exp_f32 v147, v147
  ds_read_b128 v[8:11], v124 offset:5120
  s_mov_b64 exec, s[46:47]
  ds_read_b128 v[228:231], v239 offset:10240
  ds_read_b128 v[232:235], v239 offset:11264
  s_mov_b64 exec, -1
  v_exp_f32 v148, v148
  v_exp_f32 v149, v149
  v_smfmac_f32_32x32x32_bf16 v[172:187], v[220:223], v[140:147], v236
  v_exp_f32 v150, v150
  v_exp_f32 v151, v151
  v_exp_f32 v152, v152
  v_exp_f32 v153, v153
  v_exp_f32 v154, v154
  v_exp_f32 v155, v155
  v_exp_f32 v156, v156
  v_exp_f32 v157, v157
  v_smfmac_f32_32x32x32_bf16 v[172:187], v[224:227], v[148:155], v236
  v_exp_f32 v158, v158
  v_exp_f32 v159, v159
  v_exp_f32 v160, v160
  s_waitcnt lgkmcnt(0)
  v_mfma_f32_32x32x16_bf16 v[140:155], v[8:11], v[132:135], 4.0
  v_exp_f32 v161, v161
  v_exp_f32 v162, v162
  v_exp_f32 v163, v163
  v_exp_f32 v164, v164
  v_exp_f32 v165, v165
  v_smfmac_f32_32x32x32_bf16 v[188:203], v[220:223], v[156:163], v236
  v_exp_f32 v166, v166
  v_exp_f32 v167, v167
  v_exp_f32 v168, v168
  v_exp_f32 v169, v169
  v_exp_f32 v170, v170
  v_exp_f32 v171, v171
  s_cmp_lg_u32 s27, 0
  s_cbranch_scc1 own_skip5_0
  s_waitcnt vmcnt(0)
  v_cmp_eq_u32 vcc, s51, v248
  s_nop 1
  s_cmp_eq_u64 vcc, -1
  s_cbranch_scc1 own0_ok
  s_mov_b32 s98, 0
own0_spin:
  s_add_u32 s98, s98, 1
  s_cmp_gt_u32 s98, 0x1000000
  s_cbranch_scc1 own0_ok
  buffer_load_dword v248, v249, s[16:19], s50 offen sc1
  s_waitcnt vmcnt(0)
  v_cmp_eq_u32 vcc, s51, v248
  s_nop 1
  s_cmp_eq_u64 vcc, -1
  s_cbranch_scc0 own0_spin
own0_ok:
  buffer_load_dwordx4 v[204:207], v237, s[16:19], s52 offen offset:0 sc1
  buffer_load_dwordx4 v[208:211], v237, s[16:19], s52 offen offset:1024 sc1
  buffer_load_dwordx4 v[212:215], v237, s[16:19], s52 offen offset:2048 sc1
  buffer_load_dwordx4 v[216:219], v237, s[16:19], s52 offen offset:3072 sc1
  s_add_u32 s30, s26, 1
  s_and_b32 s30, s30, 7
  s_lshl_b32 s30, s30, 14
  s_lshl_b32 s29, s28, 12
  s_add_u32 s30, s30, s29
  s_mov_b32 m0, s30
  s_add_u32 s30, s30, s57
  buffer_load_dwordx4 v237, s[16:19], s30 offen offset:0 sc1 lds
  buffer_load_dwordx4 v237, s[16:19], s30 offen offset:1024 sc1 lds
  buffer_load_dwordx4 v237, s[16:19], s30 offen offset:2048 sc1 lds
  buffer_load_dwordx4 v237, s[16:19], s30 offen offset:3072 sc1 lds
own_skip5_0:
  s_cmp_lg_u32 s27, 1
  s_cbranch_scc1 own_skip5_1
  s_waitcnt vmcnt(0)
  v_cmp_eq_u32 vcc, s51, v248
  s_nop 1
  s_cmp_eq_u64 vcc, -1
  s_cbranch_scc1 own1_ok
  s_mov_b32 s98, 0
own1_spin:
  s_add_u32 s98, s98, 1
  s_cmp_gt_u32 s98, 0x1000000
  s_cbranch_scc1 own1_ok
  buffer_load_dword v248, v249, s[16:19], s50 offen sc1
  s_waitcnt vmcnt(0)
  v_cmp_eq_u32 vcc, s51, v248
  s_nop 1
  s_cmp_eq_u64 vcc, -1
  s_cbranch_scc0 own1_spin
own1_ok:
  buffer_load_dwordx4 v[204:207], v237, s[16:19], s52 offen offset:0 sc1
  buffer_load_dwordx4 v[208:211], v237, s[16:19], s52 offen offset:1024 sc1
  buffer_load_dwordx4 v[212:215], v237, s[16:19], s52 offen offset:2048 sc1
  buffer_load_dwordx4 v[216:219], v237, s[16:19], s52 offen offset:3072 sc1
own_skip5_1:
  s_setprio 0
  v_exp_f32 v140, v140
  v_exp_f32 v141, v141
  v_smfmac_f32_32x32x32_bf16 v[188:203], v[224:227], v[164:171], v236
  v_exp_f32 v142, v142
  v_exp_f32 v143, v143
  v_exp_f32 v144, v144
  v_mfma_f32_32x32x16_bf16 v[156:171], v[8:11], v[136:139], 4.0
  v_exp_f32 v145, v145
  v_exp_f32 v146, v146
  v_exp_f32 v147, v147
  ds_read_b128 v[4:7], v124 offset:6144
  s_mov_b64 exec, s[46:47]
  ds_read_b128 v[220:223], v239 offset:12288
  ds_read_b128 v[224:227], v239 offset:13312
  s_mov_b64 exec, -1
  v_exp_f32 v148, v148
  v_exp_f32 v149, v149
  v_smfmac_f32_32x32x32_bf16 v[172:187], v[228:231], v[140:147], v236
  v_exp_f32 v150, v150
  v_exp_f32 v151, v151
  v_exp_f32 v152, v152
  v_exp_f32 v153, v153
  v_exp_f32 v154, v154
  v_exp_f32 v155, v155
  v_exp_f32 v156, v156
  v_exp_f32 v157, v157
  v_smfmac_f32_32x32x32_bf16 v[172:187], v[232:235], v[148:155], v236
  v_exp_f32 v158, v158
  v_exp_f32 v159, v159
  v_exp_f32 v160, v160
  s_waitcnt lgkmcnt(0)
  v_mfma_f32_32x32x16_bf16 v[140:155], v[4:7], v[132:135], 4.0
  v_exp_f32 v161, v161
  v_exp_f32 v162, v162
  v_exp_f32 v163, v163
  v_exp_f32 v164, v164
  v_exp_f32 v165, v165
  v_smfmac_f32_32x32x32_bf16 v[188:203], v[228:231], v[156:163], v236
  v_exp_f32 v166, v166
  v_exp_f32 v167, v167
  v_exp_f32 v168, v168
  v_exp_f32 v169, v169
  v_exp_f32 v170, v170
  v_exp_f32 v171, v171
  v_exp_f32 v140, v140
  v_exp_f32 v141, v141
  v_smfmac_f32_32x32x32_bf16 v[188:203], v[232:235], v[164:171], v236
  v_exp_f32 v142, v142
  v_exp_f32 v143, v143
  v_exp_f32 v144, v144
  v_mfma_f32_32x32x16_bf16 v[156:171], v[4:7], v[136:139], 4.0
  v_exp_f32 v145, v145
  v_exp_f32 v146, v146
  v_exp_f32 v147, v147
  ds_read_b128 v[8:11], v124 offset:7168
  s_mov_b64 exec, s[46:47]
  ds_read_b128 v[228:231], v239 offset:14336
  ds_read_b128 v[232:235], v239 offset:15360
  s_mov_b64 exec, -1
  v_exp_f32 v148, v148
  v_exp_f32 v149, v149
  v_smfmac_f32_32x32x32_bf16 v[172:187], v[220:223], v[140:147], v236
  v_exp_f32 v150, v150
  v_exp_f32 v151, v151
  v_exp_f32 v152, v152
  v_exp_f32 v153, v153
  v_exp_f32 v154, v154
  v_exp_f32 v155, v155
  v_exp_f32 v156, v156
  v_exp_f32 v157, v157
  v_smfmac_f32_32x32x32_bf16 v[172:187], v[224:227], v[148:155], v236
  v_exp_f32 v158, v158
  v_exp_f32 v159, v159
  v_exp_f32 v160, v160
  s_waitcnt lgkmcnt(0)
  v_mfma_f32_32x32x16_bf16 v[140:155], v[8:11], v[132:135], 4.0
  v_exp_f32 v161, v161
  v_exp_f32 v162, v162
  v_exp_f32 v163, v163
  v_exp_f32 v164, v164
  v_exp_f32 v165, v165
  v_smfmac_f32_32x32x32_bf16 v[188:203], v[220:223], v[156:163], v236
  v_exp_f32 v166, v166
  v_exp_f32 v167, v167
  v_exp_f32 v168, v168
  v_exp_f32 v169, v169
  v_exp_f32 v170, v170
  v_exp_f32 v171, v171
  v_add_u32 v239, s53, v238
  s_lshl_b32 s99, s3, 11
  s_add_u32 s100, s57, s99
  v_exp_f32 v140, v140
  v_exp_f32 v141, v141
  v_smfmac_f32_32x32x32_bf16 v[188:203], v[224:227], v[164:171], v236
  v_exp_f32 v142, v142
  v_exp_f32 v143, v143
  v_exp_f32 v144, v144
  v_mfma_f32_32x32x16_bf16 v[156:171], v[8:11], v[136:139], 4.0
  v_exp_f32 v145, v145
  v_exp_f32 v146, v146
  v_exp_f32 v147, v147
  v_exp_f32 v148, v148
  v_exp_f32 v149, v149
  s_waitcnt lgkmcnt(0)
  v_smfmac_f32_32x32x32_bf16 v[172:187], v[228:231], v[140:147], v236
  v_exp_f32 v150, v150
  v_exp_f32 v151, v151
  v_exp_f32 v152, v152
  v_exp_f32 v153, v153
  v_exp_f32 v154, v154
  v_exp_f32 v155, v155
  v_exp_f32 v156, v156
  v_exp_f32 v157, v157
  v_smfmac_f32_32x32x32_bf16 v[172:187], v[232:235], v[148:155], v236
  v_exp_f32 v158, v158
  v_exp_f32 v159, v159
  v_exp_f32 v160, v160
  s_waitcnt vmcnt(3)
  v_mfma_f32_32x32x16_bf16 v[140:155], v[204:207], v[132:135], 4.0
  v_exp_f32 v161, v161
  v_exp_f32 v162, v162
  v_exp_f32 v163, v163
  v_exp_f32 v164, v164
  v_exp_f32 v165, v165
  v_smfmac_f32_32x32x32_bf16 v[188:203], v[228:231], v[156:163], v236
  v_exp_f32 v166, v166
  v_exp_f32 v167, v167
  v_exp_f32 v168, v168
  v_exp_f32 v169, v169
  s_add_u32 s54, s54, 4096
  s_and_b32 s54, s54, 0xffff
  s_add_u32 s52, s54, s48
  s_lshl_b32 s53, s54, 1
  v_exp_f32 v170, v170
  v_exp_f32 v171, v171
  s_waitcnt vmcnt(0)
  s_barrier
  s_mov_b64 exec, s[46:47]
  ds_read_b128 v[220:223], v239 offset:0
  ds_read_b128 v[224:227], v239 offset:1024
  s_mov_b64 exec, -1
  v_and_b32 v249, 0x380, v240
  buffer_load_dword v248, v249, s[16:19], s50 offen sc1
  v_exp_f32 v140, v140
  v_exp_f32 v141, v141
  v_smfmac_f32_32x32x32_bf16 v[188:203], v[232:235], v[164:171], v236
  v_exp_f32 v142, v142
  v_exp_f32 v143, v143
  v_exp_f32 v144, v144
  v_mfma_f32_32x32x16_bf16 v[156:171], v[204:207], v[136:139], 4.0
  v_exp_f32 v145, v145
  v_exp_f32 v146, v146
  v_exp_f32 v147, v147
  v_exp_f32 v148, v148
  v_exp_f32 v149, v149
  s_waitcnt lgkmcnt(0)
  v_smfmac_f32_32x32x32_bf16 v[172:187], v[220:223], v[140:147], v236
  v_exp_f32 v150, v150
  v_exp_f32 v151, v151
  v_exp_f32 v152, v152
  s_mov_b64 exec, s[46:47]
  ds_read_b128 v[228:231], v239 offset:2048
  ds_read_b128 v[232:235], v239 offset:3072
  s_mov_b64 exec, -1
  v_exp_f32 v153, v153
  v_exp_f32 v154, v154
  v_exp_f32 v155, v155
  v_exp_f32 v156, v156
  v_exp_f32 v157, v157
  v_smfmac_f32_32x32x32_bf16 v[172:187], v[224:227], v[148:155], v236
  v_exp_f32 v158, v158
  v_exp_f32 v159, v159
  v_exp_f32 v160, v160
  v_mfma_f32_32x32x16_bf16 v[140:155], v[208:211], v[132:135], 4.0
  v_exp_f32 v161, v161
  v_exp_f32 v162, v162
  v_exp_f32 v163, v163
  v_exp_f32 v164, v164
  v_exp_f32 v165, v165
  v_smfmac_f32_32x32x32_bf16 v[188:203], v[220:223], v[156:163], v236
  v_exp_f32 v166, v166
  v_exp_f32 v167, v167
  v_exp_f32 v168, v168
  buffer_load_dwordx4 v[204:207], v237, s[16:19], s52 offen offset:0 sc1
  v_exp_f32 v169, v169
  v_exp_f32 v170, v170
  v_exp_f32 v171, v171
  v_exp_f32 v140, v140
  v_exp_f32 v141, v141
  v_smfmac_f32_32x32x32_bf16 v[188:203], v[224:227], v[164:171], v236
  v_exp_f32 v142, v142
  v_exp_f32 v143, v143
  v_exp_f32 v144, v144
  v_mfma_f32_32x32x16_bf16 v[156:171], v[208:211], v[136:139], 4.0
  v_exp_f32 v145, v145
  v_exp_f32 v146, v146
  v_exp_f32 v147, v147
  v_exp_f32 v148, v148
  v_exp_f32 v149, v149
  s_waitcnt lgkmcnt(0)
  v_smfmac_f32_32x32x32_bf16 v[172:187], v[228:231], v[140:147], v236
  v_exp_f32 v150, v150
  v_exp_f32 v151, v151
  v_exp_f32 v152, v152
  s_mov_b64 exec, s[46:47]
  ds_read_b128 v[220:223], v239 offset:4096
  ds_read_b128 v[224:227], v239 offset:5120
  s_mov_b64 exec, -1
  v_exp_f32 v153, v153
  v_exp_f32 v154, v154
  v_exp_f32 v155, v155
  v_exp_f32 v156, v156
  v_exp_f32 v157, v157
  v_smfmac_f32_32x32x32_bf16 v[172:187], v[232:235], v[148:155], v236
  v_exp_f32 v158, v158
  v_exp_f32 v159, v159
  v_exp_f32 v160, v160
  v_mfma_f32_32x32x16_bf16 v[140:155], v[212:215], v[132:135], 4.0
  v_exp_f32 v161, v161
  v_exp_f32 v162, v162
  v_exp_f32 v163, v163
  v_exp_f32 v164, v164
  v_exp_f32 v165, v165
  v_smfmac_f32_32x32x32_bf16 v[188:203], v[228:231], v[156:163], v236
  v_exp_f32 v166, v166
  v_exp_f32 v167, v167
  v_exp_f32 v168, v168
  buffer_load_dwordx4 v[208:211], v237, s[16:19], s52 offen offset:1024 sc1
  v_exp_f32 v169, v169
  v_exp_f32 v170, v170
  v_exp_f32 v171, v171
  v_exp_f32 v140, v140
  v_exp_f32 v141, v141
  v_smfmac_f32_32x32x32_bf16 v[188:203], v[232:235], v[164:171], v236
  v_exp_f32 v142, v142
  v_exp_f32 v143, v143
  v_exp_f32 v144, v144
  v_mfma_f32_32x32x16_bf16 v[156:171], v[212:215], v[136:139], 4.0
  v_exp_f32 v145, v145
  v_exp_f32 v146, v146
  v_exp_f32 v147, v147
  v_exp_f32 v148, v148
  v_exp_f32 v149, v149
  s_waitcnt lgkmcnt(0)
  v_smfmac_f32_32x32x32_bf16 v[172:187], v[220:223], v[140:147], v236
  v_exp_f32 v150, v150
  v_exp_f32 v151, v151
  v_exp_f32 v152, v152
  s_mov_b64 exec, s[46:47]
  ds_read_b128 v[228:231], v239 offset:6144
  ds_read_b128 v[232:235], v239 offset:7168
  s_mov_b64 exec, -1
  v_exp_f32 v153, v153
  v_exp_f32 v154, v154
  v_exp_f32 v155, v155
  v_exp_f32 v156, v156
  v_exp_f32 v157, v157
  v_smfmac_f32_32x32x32_bf16 v[172:187], v[224:227], v[148:155], v236
  v_exp_f32 v158, v158
  v_exp_f32 v159, v159
  v_exp_f32 v160, v160
  v_mfma_f32_32x32x16_bf16 v[140:155], v[216:219], v[132:135], 4.0
  v_exp_f32 v161, v161
  v_exp_f32 v162, v162
  v_exp_f32 v163, v163
  v_exp_f32 v164, v164
  v_exp_f32 v165, v165
  v_smfmac_f32_32x32x32_bf16 v[188:203], v[220:223], v[156:163], v236
  v_exp_f32 v166, v166
  v_exp_f32 v167, v167
  v_exp_f32 v168, v168
  buffer_load_dwordx4 v[212:215], v237, s[16:19], s52 offen offset:2048 sc1
  v_exp_f32 v169, v169
  v_exp_f32 v170, v170
  v_exp_f32 v171, v171
  v_exp_f32 v140, v140
  v_exp_f32 v141, v141
  v_smfmac_f32_32x32x32_bf16 v[188:203], v[224:227], v[164:171], v236
  v_exp_f32 v142, v142
  v_exp_f32 v143, v143
  v_exp_f32 v144, v144
  v_mfma_f32_32x32x16_bf16 v[156:171], v[216:219], v[136:139], 4.0
  v_exp_f32 v145, v145
  v_exp_f32 v146, v146
  v_exp_f32 v147, v147
  v_exp_f32 v148, v148
  v_exp_f32 v149, v149
  s_waitcnt lgkmcnt(0)
  v_smfmac_f32_32x32x32_bf16 v[172:187], v[228:231], v[140:147], v236
  v_exp_f32 v150, v150
  v_exp_f32 v151, v151
  v_exp_f32 v152, v152
  v_add_u32 v239, s53, v238
  s_mov_b64 exec, s[46:47]
  ds_read_b128 v[220:223], v239 offset:0
  ds_read_b128 v[224:227], v239 offset:1024
  s_mov_b64 exec, -1
  v_exp_f32 v153, v153
  v_exp_f32 v154, v154
  v_exp_f32 v155, v155
  v_exp_f32 v156, v156
  v_exp_f32 v157, v157
  v_smfmac_f32_32x32x32_bf16 v[172:187], v[232:235], v[148:155], v236
  v_exp_f32 v158, v158
  v_exp_f32 v159, v159
  v_exp_f32 v160, v160
  s_waitcnt vmcnt(2)
  v_mfma_f32_32x32x16_bf16 v[140:155], v[204:207], v[132:135], 4.0
  v_exp_f32 v161, v161
  v_exp_f32 v162, v162
  v_exp_f32 v163, v163
  v_exp_f32 v164, v164
  v_exp_f32 v165, v165
  v_smfmac_f32_32x32x32_bf16 v[188:203], v[228:231], v[156:163], v236
  v_exp_f32 v166, v166
  v_exp_f32 v167, v167
  v_exp_f32 v168, v168
  buffer_load_dwordx4 v[216:219], v237, s[16:19], s52 offen offset:3072 sc1
  v_exp_f32 v169, v169
  s_add_u32 s54, s54, 4096
  s_and_b32 s54, s54, 0xffff
  s_add_u32 s52, s54, s48
  s_lshl_b32 s53, s54, 1
  v_exp_f32 v170, v170
  v_exp_f32 v171, v171
  v_cmp_eq_u32 vcc, s51, v248
  s_nop 1
  s_cmp_eq_u64 vcc, -1
  s_cbranch_scc1 all_ok
  s_mov_b32 s98, 0
all_spin:
  s_add_u32 s98, s98, 1
  s_cmp_gt_u32 s98, 0x1000000
  s_cbranch_scc1 all_ok
  buffer_load_dword v248, v249, s[16:19], s50 offen sc1
  s_waitcnt vmcnt(0)
  v_cmp_eq_u32 vcc, s51, v248
  s_nop 1
  s_cmp_eq_u64 vcc, -1
  s_cbranch_scc0 all_spin
all_ok:
  s_add_u32 s29, s26, s3
  s_cmp_lg_u32 s29, 0
  s_cbranch_scc1 att_noepoch
  s_mov_b64 exec, 1
  v_mov_b32 v250, 1024
  buffer_store_dword v241, v250, s[16:19], s50 offen sc1
  s_mov_b64 exec, -1
att_noepoch:
  s_add_u32 s30, s26, 2
  s_and_b32 s30, s30, 7
  s_lshl_b32 s30, s30, 14
  s_add_u32 m0, s30, s99
  s_add_u32 s30, s30, s100
  buffer_load_dwordx4 v237, s[16:19], s30 offen offset:0 sc1 lds
  buffer_load_dwordx4 v237, s[16:19], s30 offen offset:1024 sc1 lds
  v_exp_f32 v140, v140
  v_exp_f32 v141, v141
  v_smfmac_f32_32x32x32_bf16 v[188:203], v[232:235], v[164:171], v236
  v_exp_f32 v142, v142
  v_exp_f32 v143, v143
  v_exp_f32 v144, v144
  v_mfma_f32_32x32x16_bf16 v[156:171], v[204:207], v[136:139], 4.0
  v_exp_f32 v145, v145
  v_exp_f32 v146, v146
  v_exp_f32 v147, v147
  v_exp_f32 v148, v148
  v_exp_f32 v149, v149
  s_waitcnt lgkmcnt(0)
  v_smfmac_f32_32x32x32_bf16 v[172:187], v[220:223], v[140:147], v236
  v_exp_f32 v150, v150
  v_exp_f32 v151, v151
  v_exp_f32 v152, v152
  s_mov_b64 exec, s[46:47]
  ds_read_b128 v[228:231], v239 offset:2048
  ds_read_b128 v[232:235], v239 offset:3072
  s_mov_b64 exec, -1
  v_exp_f32 v153, v153
  v_exp_f32 v154, v154
  v_exp_f32 v155, v155
  v_exp_f32 v156, v156
  v_exp_f32 v157, v157
  v_smfmac_f32_32x32x32_bf16 v[172:187], v[224:227], v[148:155], v236
  v_exp_f32 v158, v158
  v_exp_f32 v159, v159
  v_exp_f32 v160, v160
  s_waitcnt vmcnt(4)
  v_mfma_f32_32x32x16_bf16 v[140:155], v[208:211], v[132:135], 4.0
  v_exp_f32 v161, v161
  v_exp_f32 v162, v162
  v_exp_f32 v163, v163
  v_exp_f32 v164, v164
  v_exp_f32 v165, v165
  v_smfmac_f32_32x32x32_bf16 v[188:203], v[220:223], v[156:163], v236
  v_exp_f32 v166, v166
  v_exp_f32 v167, v167
  v_exp_f32 v168, v168
  buffer_load_dwordx4 v[204:207], v237, s[16:19], s52 offen offset:0 sc1
  v_exp_f32 v169, v169
  v_exp_f32 v170, v170
  v_exp_f32 v171, v171
  s_add_u32 s30, s26, 3
  s_and_b32 s30, s30, 7
  s_lshl_b32 s30, s30, 14
  s_add_u32 m0, s30, s99
  s_add_u32 s30, s30, s100
  buffer_load_dwordx4 v237, s[16:19], s30 offen offset:0 sc1 lds
  buffer_load_dwordx4 v237, s[16:19], s30 offen offset:1024 sc1 lds
  s_add_u32 s30, s26, 4
  s_and_b32 s30, s30, 7
  s_lshl_b32 s30, s30, 14
  s_add_u32 m0, s30, s99
  s_add_u32 s30, s30, s100
  buffer_load_dwordx4 v237, s[16:19], s30 offen offset:0 sc1 lds
  buffer_load_dwordx4 v237, s[16:19], s30 offen offset:1024 sc1 lds
  v_exp_f32 v140, v140
  v_exp_f32 v141, v141
  v_smfmac_f32_32x32x32_bf16 v[188:203], v[224:227], v[164:171], v236
  v_exp_f32 v142, v142
  v_exp_f32 v143, v143
  v_exp_f32 v144, v144
  v_mfma_f32_32x32x16_bf16 v[156:171], v[208:211], v[136:139], 4.0
  v_exp_f32 v145, v145
  v_exp_f32 v146, v146
  v_exp_f32 v147, v147
  v_exp_f32 v148, v148
  v_exp_f32 v149, v149
  s_waitcnt lgkmcnt(0)
  v_smfmac_f32_32x32x32_bf16 v[172:187], v[228:231], v[140:147], v236
  v_exp_f32 v150, v150
  v_exp_f32 v151, v151
  v_exp_f32 v152, v152
  s_mov_b64 exec, s[46:47]
  ds_read_b128 v[220:223], v239 offset:4096
  ds_read_b128 v[224:227], v239 offset:5120
  s_mov_b64 exec, -1
  v_exp_f32 v153, v153
  v_exp_f32 v154, v154
  v_exp_f32 v155, v155
  v_exp_f32 v156, v156
  v_exp_f32 v157, v157
  v_smfmac_f32_32x32x32_bf16 v[172:187], v[232:235], v[148:155], v236
  v_exp_f32 v158, v158
  v_exp_f32 v159, v159
  v_exp_f32 v160, v160
  s_waitcnt vmcnt(8)
  v_mfma_f32_32x32x16_bf16 v[140:155], v[212:215], v[132:135], 4.0
  v_exp_f32 v161, v161
  v_exp_f32 v162, v162
  v_exp_f32 v163, v163
  v_exp_f32 v164, v164
  v_exp_f32 v165, v165
  v_smfmac_f32_32x32x32_bf16 v[188:203], v[228:231], v[156:163], v236
  v_exp_f32 v166, v166
  v_exp_f32 v167, v167
  v_exp_f32 v168, v168
  buffer_load_dwordx4 v[208:211], v237, s[16:19], s52 offen offset:1024 sc1
  v_exp_f32 v169, v169
  v_exp_f32 v170, v170
  v_exp_f32 v171, v171
  s_add_u32 s30, s26, 5
  s_and_b32 s30, s30, 7
  s_lshl_b32 s30, s30, 14
  s_add_u32 m0, s30, s99
  s_add_u32 s30, s30, s100
  buffer_load_dwordx4 v237, s[16:19], s30 offen offset:0 sc1 lds
  buffer_load_dwordx4 v237, s[16:19], s30 offen offset:1024 sc1 lds
  s_add_u32 s30, s26, 6
  s_and_b32 s30, s30, 7
  s_lshl_b32 s30, s30, 14
  s_add_u32 m0, s30, s99
  s_add_u32 s30, s30, s100
  buffer_load_dwordx4 v237, s[16:19], s30 offen offset:0 sc1 lds
  buffer_load_dwordx4 v237, s[16:19], s30 offen offset:1024 sc1 lds
  v_exp_f32 v140, v140
  v_exp_f32 v141, v141
  v_smfmac_f32_32x32x32_bf16 v[188:203], v[232:235], v[164:171], v236
  v_exp_f32 v142, v142
  v_exp_f32 v143, v143
  v_exp_f32 v144, v144
  v_mfma_f32_32x32x16_bf16 v[156:171], v[212:215], v[136:139], 4.0
  v_exp_f32 v145, v145
  v_exp_f32 v146, v146
  v_exp_f32 v147, v147
  v_exp_f32 v148, v148
  v_exp_f32 v149, v149
  s_waitcnt lgkmcnt(0)
  v_smfmac_f32_32x32x32_bf16 v[172:187], v[220:223], v[140:147], v236
  v_exp_f32 v150, v150
  v_exp_f32 v151, v151
  v_exp_f32 v152, v152
  s_mov_b64 exec, s[46:47]
  ds_read_b128 v[228:231], v239 offset:6144
  ds_read_b128 v[232:235], v239 offset:7168
  s_mov_b64 exec, -1
  v_exp_f32 v153, v153
  v_exp_f32 v154, v154
  v_exp_f32 v155, v155
  v_exp_f32 v156, v156
  v_exp_f32 v157, v157
  v_smfmac_f32_32x32x32_bf16 v[172:187], v[224:227], v[148:155], v236
  v_exp_f32 v158, v158
  v_exp_f32 v159, v159
  v_exp_f32 v160, v160
  s_waitcnt vmcnt(12)
  v_mfma_f32_32x32x16_bf16 v[140:155], v[216:219], v[132:135], 4.0
  v_exp_f32 v161, v161
  v_exp_f32 v162, v162
  v_exp_f32 v163, v163
  v_exp_f32 v164, v164
  v_exp_f32 v165, v165
  v_smfmac_f32_32x32x32_bf16 v[188:203], v[220:223], v[156:163], v236
  v_exp_f32 v166, v166
  v_exp_f32 v167, v167
  v_exp_f32 v168, v168
  buffer_load_dwordx4 v[212:215], v237, s[16:19], s52 offen offset:2048 sc1
  v_exp_f32 v169, v169
  v_exp_f32 v170, v170
  v_exp_f32 v171, v171
  s_waitcnt vmcnt(11)
  s_barrier
  s_add_u32 s30, s26, 7
  s_and_b32 s30, s30, 7
  s_lshl_b32 s30, s30, 14
  s_add_u32 m0, s30, s99
  s_add_u32 s30, s30, s100
  buffer_load_dwordx4 v237, s[16:19], s30 offen offset:0 sc1 lds
  buffer_load_dwordx4 v237, s[16:19], s30 offen offset:1024 sc1 lds
  v_exp_f32 v140, v140
  v_exp_f32 v141, v141
  v_smfmac_f32_32x32x32_bf16 v[188:203], v[224:227], v[164:171], v236
  v_exp_f32 v142, v142
  v_exp_f32 v143, v143
  v_exp_f32 v144, v144
  v_mfma_f32_32x32x16_bf16 v[156:171], v[216:219], v[136:139], 4.0
  v_exp_f32 v145, v145
  v_exp_f32 v146, v146
  v_exp_f32 v147, v147
  v_exp_f32 v148, v148
  v_exp_f32 v149, v149
  s_waitcnt lgkmcnt(0)
  v_smfmac_f32_32x32x32_bf16 v[172:187], v[228:231], v[140:147], v236
  v_exp_f32 v150, v150
  v_exp_f32 v151, v151
  v_exp_f32 v152, v152
  v_add_u32 v239, s53, v238
  s_mov_b64 exec, s[46:47]
  ds_read_b128 v[220:223], v239 offset:0
  ds_read_b128 v[224:227], v239 offset:1024
  s_mov_b64 exec, -1
  v_exp_f32 v153, v153
  v_exp_f32 v154, v154
  v_exp_f32 v155, v155
  v_exp_f32 v156, v156
  v_exp_f32 v157, v157
  v_smfmac_f32_32x32x32_bf16 v[172:187], v[232:235], v[148:155], v236
  v_exp_f32 v158, v158
  v_exp_f32 v159, v159
  v_exp_f32 v160, v160
  s_waitcnt vmcnt(12)
  v_mfma_f32_32x32x16_bf16 v[140:155], v[204:207], v[132:135], 4.0
  v_exp_f32 v161, v161
  v_exp_f32 v162, v162
  v_exp_f32 v163, v163
  v_exp_f32 v164, v164
  v_exp_f32 v165, v165
  v_smfmac_f32_32x32x32_bf16 v[188:203], v[228:231], v[156:163], v236
  v_exp_f32 v166, v166
  v_exp_f32 v167, v167
  v_exp_f32 v168, v168
  buffer_load_dwordx4 v[216:219], v237, s[16:19], s52 offen offset:3072 sc1
  v_exp_f32 v169, v169
  s_add_u32 s54, s54, 4096
  s_and_b32 s54, s54, 0xffff
  s_add_u32 s52, s54, s48
  s_lshl_b32 s53, s54, 1
  v_exp_f32 v170, v170
  v_exp_f32 v171, v171
  buffer_load_dwordx2 v[248:249], v240, s[16:19], s38 offen sc1
  v_exp_f32 v140, v140
  v_exp_f32 v141, v141
  v_smfmac_f32_32x32x32_bf16 v[188:203], v[232:235], v[164:171], v236
  v_exp_f32 v142, v142
  v_exp_f32 v143, v143
  v_exp_f32 v144, v144
  v_mfma_f32_32x32x16_bf16 v[156:171], v[204:207], v[136:139], 4.0
  v_exp_f32 v145, v145
  v_exp_f32 v146, v146
  v_exp_f32 v147, v147
  v_exp_f32 v148, v148
  v_exp_f32 v149, v149
  s_waitcnt lgkmcnt(0)
  v_smfmac_f32_32x32x32_bf16 v[172:187], v[220:223], v[140:147], v236
  v_exp_f32 v150, v150
  v_exp_f32 v151, v151
  v_exp_f32 v152, v152
  s_mov_b64 exec, s[46:47]
  ds_read_b128 v[228:231], v239 offset:2048
  ds_read_b128 v[232:235], v239 offset:3072
  s_mov_b64 exec, -1
  v_exp_f32 v153, v153
  v_exp_f32 v154, v154
  v_exp_f32 v155, v155
  v_exp_f32 v156, v156
  v_exp_f32 v157, v157
  v_smfmac_f32_32x32x32_bf16 v[172:187], v[224:227], v[148:155], v236
  v_exp_f32 v158, v158
  v_exp_f32 v159, v159
  v_exp_f32 v160, v160
  s_waitcnt vmcnt(9)
  v_mfma_f32_32x32x16_bf16 v[140:155], v[208:211], v[132:135], 4.0
  v_exp_f32 v161, v161
  v_exp_f32 v162, v162
  v_exp_f32 v163, v163
  v_exp_f32 v164, v164
  v_exp_f32 v165, v165
  v_smfmac_f32_32x32x32_bf16 v[188:203], v[220:223], v[156:163], v236
  v_exp_f32 v166, v166
  v_exp_f32 v167, v167
  v_exp_f32 v168, v168
  buffer_load_dwordx4 v[204:207], v237, s[16:19], s52 offen offset:0 sc1
  v_exp_f32 v169, v169
  s_and_b32 s29, s26, 1
  s_lshl_b32 s29, s29, 3
  s_lshr_b32 s30, s25, 1
  s_add_u32 s29, s29, s30
  s_lshl_b32 s29, s29, 3
  s_add_u32 s29, s29, s3
  s_lshl_b32 s29, s29, 12
  s_and_b32 s30, s25, 1
  s_lshl_b32 s30, s30, 9
  s_add_u32 s29, s29, s30
  v_lshrrev_b32 v250, 2, v0
  v_lshlrev_b32 v250, 10, v250
  v_and_b32 v251, 3, v0
  v_lshl_add_u32 v250, v251, 7, v250
  s_mov_b64 exec, 0xffff
  buffer_load_dword v252, v250, s[12:15], s29 offen
  s_mov_b64 exec, -1
  v_exp_f32 v170, v170
  v_exp_f32 v171, v171
  v_exp_f32 v140, v140
  v_exp_f32 v141, v141
  v_smfmac_f32_32x32x32_bf16 v[188:203], v[224:227], v[164:171], v236
  v_exp_f32 v142, v142
  v_exp_f32 v143, v143
  v_exp_f32 v144, v144
  v_mfma_f32_32x32x16_bf16 v[156:171], v[208:211], v[136:139], 4.0
  v_exp_f32 v145, v145
  v_exp_f32 v146, v146
  v_exp_f32 v147, v147
  v_exp_f32 v148, v148
  v_exp_f32 v149, v149
  s_waitcnt lgkmcnt(0)
  v_smfmac_f32_32x32x32_bf16 v[172:187], v[228:231], v[140:147], v236
  v_exp_f32 v150, v150
  v_exp_f32 v151, v151
  v_exp_f32 v152, v152
  s_mov_b64 exec, s[46:47]
  ds_read_b128 v[220:223], v239 offset:4096
  ds_read_b128 v[224:227], v239 offset:5120
  s_mov_b64 exec, -1
  v_exp_f32 v153, v153
  v_exp_f32 v154, v154
  v_exp_f32 v155, v155
  v_exp_f32 v156, v156
  v_exp_f32 v157, v157
  v_smfmac_f32_32x32x32_bf16 v[172:187], v[232:235], v[148:155], v236
  v_exp_f32 v158, v158
  v_exp_f32 v159, v159
  v_exp_f32 v160, v160
  s_waitcnt vmcnt(6)
  v_mfma_f32_32x32x16_bf16 v[140:155], v[212:215], v[132:135], 4.0
  v_exp_f32 v161, v161
  v_exp_f32 v162, v162
  v_exp_f32 v163, v163
  v_exp_f32 v164, v164
  v_exp_f32 v165, v165
  v_smfmac_f32_32x32x32_bf16 v[188:203], v[228:231], v[156:163], v236
  v_exp_f32 v166, v166
  v_exp_f32 v167, v167
  v_exp_f32 v168, v168
  buffer_load_dwordx4 v[208:211], v237, s[16:19], s52 offen offset:1024 sc1
  v_exp_f32 v169, v169
  v_exp_f32 v170, v170
  v_exp_f32 v171, v171
  v_exp_f32 v140, v140
  v_exp_f32 v141, v141
  v_smfmac_f32_32x32x32_bf16 v[188:203], v[232:235], v[164:171], v236
  v_exp_f32 v142, v142
  v_exp_f32 v143, v143
  v_exp_f32 v144, v144
  v_mfma_f32_32x32x16_bf16 v[156:171], v[212:215], v[136:139], 4.0
  v_exp_f32 v145, v145
  v_exp_f32 v146, v146
  v_exp_f32 v147, v147
  v_exp_f32 v148, v148
  v_exp_f32 v149, v149
  s_waitcnt lgkmcnt(0)
  v_smfmac_f32_32x32x32_bf16 v[172:187], v[220:223], v[140:147], v236
  v_exp_f32 v150, v150
  v_exp_f32 v151, v151
  v_exp_f32 v152, v152
  s_mov_b64 exec, s[46:47]
  ds_read_b128 v[228:231], v239 offset:6144
  ds_read_b128 v[232:235], v239 offset:7168
  s_mov_b64 exec, -1
  v_exp_f32 v153, v153
  v_exp_f32 v154, v154
  v_exp_f32 v155, v155
  v_exp_f32 v156, v156
  v_exp_f32 v157, v157
  v_smfmac_f32_32x32x32_bf16 v[172:187], v[224:227], v[148:155], v236
  v_exp_f32 v158, v158
  v_exp_f32 v159, v159
  v_exp_f32 v160, v160
  s_waitcnt vmcnt(4)
  v_mfma_f32_32x32x16_bf16 v[140:155], v[216:219], v[132:135], 4.0
  v_exp_f32 v161, v161
  v_exp_f32 v162, v162
  v_exp_f32 v163, v163
  v_exp_f32 v164, v164
  v_exp_f32 v165, v165
  v_smfmac_f32_32x32x32_bf16 v[188:203], v[220:223], v[156:163], v236
  v_exp_f32 v166, v166
  v_exp_f32 v167, v167
  v_exp_f32 v168, v168
  buffer_load_dwordx4 v[212:215], v237, s[16:19], s52 offen offset:2048 sc1
  v_exp_f32 v169, v169
  v_exp_f32 v170, v170
  v_exp_f32 v171, v171
  v_exp_f32 v140, v140
  v_exp_f32 v141, v141
  v_smfmac_f32_32x32x32_bf16 v[188:203], v[224:227], v[164:171], v236
  v_exp_f32 v142, v142
  v_exp_f32 v143, v143
  v_exp_f32 v144, v144
  v_mfma_f32_32x32x16_bf16 v[156:171], v[216:219], v[136:139], 4.0
  v_exp_f32 v145, v145
  v_exp_f32 v146, v146
  v_exp_f32 v147, v147
  v_exp_f32 v148, v148
  v_exp_f32 v149, v149
  s_waitcnt lgkmcnt(0)
  v_smfmac_f32_32x32x32_bf16 v[172:187], v[228:231], v[140:147], v236
  v_exp_f32 v150, v150
  v_exp_f32 v151, v151
  v_exp_f32 v152, v152
  v_add_u32 v239, s53, v238
  s_mov_b64 exec, s[46:47]
  ds_read_b128 v[220:223], v239 offset:0
  ds_read_b128 v[224:227], v239 offset:1024
  s_mov_b64 exec, -1
  v_exp_f32 v153, v153
  v_exp_f32 v154, v154
  v_exp_f32 v155, v155
  v_exp_f32 v156, v156
  v_exp_f32 v157, v157
  v_smfmac_f32_32x32x32_bf16 v[172:187], v[232:235], v[148:155], v236
  v_exp_f32 v158, v158
  v_exp_f32 v159, v159
  v_exp_f32 v160, v160
  s_waitcnt vmcnt(3)
  v_mfma_f32_32x32x16_bf16 v[140:155], v[204:207], v[132:135], 4.0
  v_exp_f32 v161, v161
  v_exp_f32 v162, v162
  v_exp_f32 v163, v163
  v_exp_f32 v164, v164
  v_exp_f32 v165, v165
  v_smfmac_f32_32x32x32_bf16 v[188:203], v[228:231], v[156:163], v236
  v_exp_f32 v166, v166
  v_exp_f32 v167, v167
  v_exp_f32 v168, v168
  buffer_load_dwordx4 v[216:219], v237, s[16:19], s52 offen offset:3072 sc1
  v_exp_f32 v169, v169
  s_add_u32 s54, s54, 4096
  s_and_b32 s54, s54, 0xffff
  s_add_u32 s52, s54, s48
  s_lshl_b32 s53, s54, 1
  v_exp_f32 v170, v170
  v_exp_f32 v171, v171
  v_cmp_eq_u32 vcc, s39, v248
  s_nop 1
  s_cmp_eq_u64 vcc, -1
  s_cbranch_scc1 mrk_ok
  s_mov_b32 s98, 0
mrk_spin:
  s_add_u32 s98, s98, 1
  s_cmp_gt_u32 s98, 0x1000000
  s_cbranch_scc1 mrk_ok
  buffer_load_dwordx2 v[248:249], v240, s[16:19], s38 offen sc1
  s_waitcnt vmcnt(0)
  v_cmp_eq_u32 vcc, s39, v248
  s_nop 1
  s_cmp_eq_u64 vcc, -1
  s_cbranch_scc0 mrk_spin
mrk_ok:
  s_xor_b32 s29, s39, s101
  v_cmp_eq_u32 vcc, s29, v249
  s_nop 1
  s_cmp_eq_u64 vcc, -1
  s_cselect_b32 s43, 1, 0
  s_add_u32 s29, s25, s3
  s_cmp_lg_u32 s29, 0
  s_cbranch_scc1 att_noepoch2
  s_mov_b64 exec, 1
  v_mov_b32 v250, 2048
  v_mov_b32 v251, s39
  buffer_store_dword v251, v250, s[16:19], s38 offen sc1
  s_mov_b64 exec, -1
att_noepoch2:
  s_barrier
  s_cmp_eq_u32 s27, 0
  s_cbranch_scc1 att_noprio
  s_setprio 1
att_noprio:
  v_exp_f32 v140, v140
  v_exp_f32 v141, v141
  v_smfmac_f32_32x32x32_bf16 v[188:203], v[232:235], v[164:171], v236
  v_exp_f32 v142, v142
  v_exp_f32 v143, v143
  v_exp_f32 v144, v144
  v_mfma_f32_32x32x16_bf16 v[156:171], v[204:207], v[136:139], 4.0
  v_exp_f32 v145, v145
  v_exp_f32 v146, v146
  v_exp_f32 v147, v147
  v_exp_f32 v148, v148
  v_exp_f32 v149, v149
  s_waitcnt lgkmcnt(0)
  v_smfmac_f32_32x32x32_bf16 v[172:187], v[220:223], v[140:147], v236
  v_exp_f32 v150, v150
  v_exp_f32 v151, v151
  v_exp_f32 v152, v152
  s_mov_b64 exec, s[46:47]
  ds_read_b128 v[228:231], v239 offset:2048
  ds_read_b128 v[232:235], v239 offset:3072
  s_mov_b64 exec, -1
  v_exp_f32 v153, v153
  v_exp_f32 v154, v154
  v_exp_f32 v155, v155
  v_exp_f32 v156, v156
  v_exp_f32 v157, v157
  v_smfmac_f32_32x32x32_bf16 v[172:187], v[224:227], v[148:155], v236
  v_exp_f32 v158, v158
  v_exp_f32 v159, v159
  v_exp_f32 v160, v160
  s_waitcnt vmcnt(2)
  v_mfma_f32_32x32x16_bf16 v[140:155], v[208:211], v[132:135], 4.0
  v_exp_f32 v161, v161
  v_exp_f32 v162, v162
  v_exp_f32 v163, v163
  v_exp_f32 v164, v164
  v_exp_f32 v165, v165
  v_smfmac_f32_32x32x32_bf16 v[188:203], v[220:223], v[156:163], v236
  v_exp_f32 v166, v166
  v_exp_f32 v167, v167
  v_exp_f32 v168, v168
  buffer_load_dwordx4 v[204:207], v237, s[16:19], s52 offen offset:0 sc1
  v_exp_f32 v169, v169
  v_exp_f32 v170, v170
  v_exp_f32 v171, v171
  s_mov_b32 m0, s6
  s_add_u32 s41, s7, 0
  buffer_load_dwordx4 v243, s[12:15], s41 offen offset:0 lds
  s_add_u32 s41, s7, 15360
  buffer_load_dwordx4 v243, s[12:15], s41 offen offset:1024 lds
  s_add_u32 s41, s7, 30720
  buffer_load_dwordx4 v243, s[12:15], s41 offen offset:2048 lds
  s_add_u32 s41, s7, 46080
  buffer_load_dwordx4 v243, s[12:15], s41 offen offset:3072 lds
  v_exp_f32 v140, v140
  v_exp_f32 v141, v141
  v_smfmac_f32_32x32x32_bf16 v[188:203], v[224:227], v[164:171], v236
  v_exp_f32 v142, v142
  v_exp_f32 v143, v143
  v_exp_f32 v144, v144
  v_mfma_f32_32x32x16_bf16 v[156:171], v[208:211], v[136:139], 4.0
  v_exp_f32 v145, v145
  v_exp_f32 v146, v146
  v_exp_f32 v147, v147
  v_exp_f32 v148, v148
  v_exp_f32 v149, v149
  s_waitcnt lgkmcnt(0)
  v_smfmac_f32_32x32x32_bf16 v[172:187], v[228:231], v[140:147], v236
  v_exp_f32 v150, v150
  v_exp_f32 v151, v151
  v_exp_f32 v152, v152
  s_mov_b64 exec, s[46:47]
  ds_read_b128 v[220:223], v239 offset:4096
  ds_read_b128 v[224:227], v239 offset:5120
  s_mov_b64 exec, -1
  v_exp_f32 v153, v153
  v_exp_f32 v154, v154
  v_exp_f32 v155, v155
  v_exp_f32 v156, v156
  v_exp_f32 v157, v157
  v_smfmac_f32_32x32x32_bf16 v[172:187], v[232:235], v[148:155], v236
  v_exp_f32 v158, v158
  v_exp_f32 v159, v159
  v_exp_f32 v160, v160
  s_waitcnt vmcnt(6)
  v_mfma_f32_32x32x16_bf16 v[140:155], v[212:215], v[132:135], 4.0
  v_exp_f32 v161, v161
  v_exp_f32 v162, v162
  v_exp_f32 v163, v163
  v_exp_f32 v164, v164
  v_exp_f32 v165, v165
  v_smfmac_f32_32x32x32_bf16 v[188:203], v[228:231], v[156:163], v236
  v_exp_f32 v166, v166
  v_exp_f32 v167, v167
  v_exp_f32 v168, v168
  buffer_load_dwordx4 v[208:211], v237, s[16:19], s52 offen offset:1024 sc1
  v_exp_f32 v169, v169
  v_exp_f32 v170, v170
  v_exp_f32 v171, v171
  v_exp_f32 v140, v140
  v_exp_f32 v141, v141
  v_smfmac_f32_32x32x32_bf16 v[188:203], v[232:235], v[164:171], v236
  v_exp_f32 v142, v142
  v_exp_f32 v143, v143
  v_exp_f32 v144, v144
  v_mfma_f32_32x32x16_bf16 v[156:171], v[212:215], v[136:139], 4.0
  v_exp_f32 v145, v145
  v_exp_f32 v146, v146
  v_exp_f32 v147, v147
  v_exp_f32 v148, v148
  v_exp_f32 v149, v149
  s_waitcnt lgkmcnt(0)
  v_smfmac_f32_32x32x32_bf16 v[172:187], v[220:223], v[140:147], v236
  v_exp_f32 v150, v150
  v_exp_f32 v151, v151
  v_exp_f32 v152, v152
  s_mov_b64 exec, s[46:47]
  ds_read_b128 v[228:231], v239 offset:6144
  ds_read_b128 v[232:235], v239 offset:7168
  s_mov_b64 exec, -1
  v_exp_f32 v153, v153
  v_exp_f32 v154, v154
  v_exp_f32 v155, v155
  v_exp_f32 v156, v156
  v_exp_f32 v157, v157
  v_smfmac_f32_32x32x32_bf16 v[172:187], v[224:227], v[148:155], v236
  v_exp_f32 v158, v158
  v_exp_f32 v159, v159
  v_exp_f32 v160, v160
  s_waitcnt vmcnt(6)
  v_mfma_f32_32x32x16_bf16 v[140:155], v[216:219], v[132:135], 4.0
  v_exp_f32 v161, v161
  v_exp_f32 v162, v162
  v_exp_f32 v163, v163
  v_exp_f32 v164, v164
  v_exp_f32 v165, v165
  v_smfmac_f32_32x32x32_bf16 v[188:203], v[220:223], v[156:163], v236
  v_exp_f32 v166, v166
  v_exp_f32 v167, v167
  v_exp_f32 v168, v168
  buffer_load_dwordx4 v[212:215], v237, s[16:19], s52 offen offset:2048 sc1
  v_exp_f32 v169, v169
  v_exp_f32 v170, v170
  v_exp_f32 v171, v171
  v_exp_f32 v140, v140
  v_exp_f32 v141, v141
  v_smfmac_f32_32x32x32_bf16 v[188:203], v[224:227], v[164:171], v236
  v_exp_f32 v142, v142
  v_exp_f32 v143, v143
  v_exp_f32 v144, v144
  v_mfma_f32_32x32x16_bf16 v[156:171], v[216:219], v[136:139], 4.0
  v_exp_f32 v145, v145
  v_exp_f32 v146, v146
  v_exp_f32 v147, v147
  v_exp_f32 v148, v148
  v_exp_f32 v149, v149
  s_waitcnt lgkmcnt(0)
  v_smfmac_f32_32x32x32_bf16 v[172:187], v[228:231], v[140:147], v236
  v_exp_f32 v150, v150
  v_exp_f32 v151, v151
  v_exp_f32 v152, v152
  v_add_u32 v239, s53, v238
  s_mov_b64 exec, s[46:47]
  ds_read_b128 v[220:223], v239 offset:0
  ds_read_b128 v[224:227], v239 offset:1024
  s_mov_b64 exec, -1
  v_exp_f32 v153, v153
  v_exp_f32 v154, v154
  v_exp_f32 v155, v155
  v_exp_f32 v156, v156
  v_exp_f32 v157, v157
  v_smfmac_f32_32x32x32_bf16 v[172:187], v[232:235], v[148:155], v236
  v_exp_f32 v158, v158
  v_exp_f32 v159, v159
  v_exp_f32 v160, v160
  s_waitcnt vmcnt(6)
  v_mfma_f32_32x32x16_bf16 v[140:155], v[204:207], v[132:135], 4.0
  v_exp_f32 v161, v161
  v_exp_f32 v162, v162
  v_exp_f32 v163, v163
  v_exp_f32 v164, v164
  v_exp_f32 v165, v165
  v_smfmac_f32_32x32x32_bf16 v[188:203], v[228:231], v[156:163], v236
  v_exp_f32 v166, v166
  v_exp_f32 v167, v167
  v_exp_f32 v168, v168
  buffer_load_dwordx4 v[216:219], v237, s[16:19], s52 offen offset:3072 sc1
  v_exp_f32 v169, v169
  s_add_u32 s54, s54, 4096
  s_and_b32 s54, s54, 0xffff
  s_add_u32 s52, s54, s48
  s_lshl_b32 s53, s54, 1
  v_exp_f32 v170, v170
  v_exp_f32 v171, v171
  s_waitcnt vmcnt(3)
  ds_read_b64_tr_b16 v[4:5], v244 offset:0
  ds_read_b64_tr_b16 v[6:7], v244 offset:512
  ds_read_b64_tr_b16 v[8:9], v245 offset:0
  ds_read_b64_tr_b16 v[10:11], v245 offset:512
  v_exp_f32 v140, v140
  v_exp_f32 v141, v141
  v_smfmac_f32_32x32x32_bf16 v[188:203], v[232:235], v[164:171], v236
  v_exp_f32 v142, v142
  v_exp_f32 v143, v143
  v_exp_f32 v144, v144
  v_mfma_f32_32x32x16_bf16 v[156:171], v[204:207], v[136:139], 4.0
  v_exp_f32 v145, v145
  v_exp_f32 v146, v146
  ds_read_b64_tr_b16 v[12:13], v244 offset:2048
  ds_read_b64_tr_b16 v[14:15], v244 offset:2560
  ds_read_b64_tr_b16 v[16:17], v245 offset:2048
  ds_read_b64_tr_b16 v[18:19], v245 offset:2560
  v_exp_f32 v147, v147
  v_exp_f32 v148, v148
  v_exp_f32 v149, v149
  s_waitcnt lgkmcnt(0)
  v_smfmac_f32_32x32x32_bf16 v[172:187], v[220:223], v[140:147], v236
  v_exp_f32 v150, v150
  v_exp_f32 v151, v151
  v_exp_f32 v152, v152
  s_mov_b64 exec, s[46:47]
  ds_read_b128 v[228:231], v239 offset:2048
  ds_read_b128 v[232:235], v239 offset:3072
  s_mov_b64 exec, -1
  v_exp_f32 v153, v153
  v_exp_f32 v154, v154
  v_exp_f32 v155, v155
  v_exp_f32 v156, v156
  v_exp_f32 v157, v157
  v_smfmac_f32_32x32x32_bf16 v[172:187], v[224:227], v[148:155], v236
  v_exp_f32 v158, v158
  v_exp_f32 v159, v159
  v_exp_f32 v160, v160
  s_waitcnt vmcnt(2)
  v_mfma_f32_32x32x16_bf16 v[140:155], v[208:211], v[132:135], 4.0
  v_exp_f32 v161, v161
  v_exp_f32 v162, v162
  v_exp_f32 v163, v163
  v_exp_f32 v164, v164
  v_exp_f32 v165, v165
  v_smfmac_f32_32x32x32_bf16 v[188:203], v[220:223], v[156:163], v236
  v_exp_f32 v166, v166
  v_exp_f32 v167, v167
  v_exp_f32 v168, v168
  buffer_load_dwordx4 v[204:207], v237, s[16:19], s52 offen offset:0 sc1
  v_exp_f32 v169, v169
  v_exp_f32 v170, v170
  v_exp_f32 v171, v171
  s_mov_b32 m0, s6
  s_add_u32 s41, s7, 65536
  buffer_load_dwordx4 v243, s[12:15], s41 offen offset:0 lds
  s_add_u32 s41, s7, 80896
  buffer_load_dwordx4 v243, s[12:15], s41 offen offset:1024 lds
  s_add_u32 s41, s7, 96256
  buffer_load_dwordx4 v243, s[12:15], s41 offen offset:2048 lds
  s_add_u32 s41, s7, 111616
  buffer_load_dwordx4 v243, s[12:15], s41 offen offset:3072 lds
  v_exp_f32 v140, v140
  v_exp_f32 v141, v141
  v_smfmac_f32_32x32x32_bf16 v[188:203], v[224:227], v[164:171], v236
  v_exp_f32 v142, v142
  v_exp_f32 v143, v143
  v_exp_f32 v144, v144
  v_mfma_f32_32x32x16_bf16 v[156:171], v[208:211], v[136:139], 4.0
  v_exp_f32 v145, v145
  v_exp_f32 v146, v146
  v_exp_f32 v147, v147
  v_exp_f32 v148, v148
  v_exp_f32 v149, v149
  s_waitcnt lgkmcnt(0)
  v_smfmac_f32_32x32x32_bf16 v[172:187], v[228:231], v[140:147], v236
  v_exp_f32 v150, v150
  v_exp_f32 v151, v151
  v_exp_f32 v152, v152
  s_mov_b64 exec, s[46:47]
  ds_read_b128 v[220:223], v239 offset:4096
  ds_read_b128 v[224:227], v239 offset:5120
  s_mov_b64 exec, -1
  v_exp_f32 v153, v153
  v_exp_f32 v154, v154
  v_exp_f32 v155, v155
  v_exp_f32 v156, v156
  v_exp_f32 v157, v157
  v_smfmac_f32_32x32x32_bf16 v[172:187], v[232:235], v[148:155], v236
  v_exp_f32 v158, v158
  v_exp_f32 v159, v159
  v_exp_f32 v160, v160
  s_waitcnt vmcnt(6)
  v_mfma_f32_32x32x16_bf16 v[140:155], v[212:215], v[132:135], 4.0
  v_exp_f32 v161, v161
  v_exp_f32 v162, v162
  v_exp_f32 v163, v163
  v_exp_f32 v164, v164
  v_exp_f32 v165, v165
  v_smfmac_f32_32x32x32_bf16 v[188:203], v[228:231], v[156:163], v236
  v_exp_f32 v166, v166
  v_exp_f32 v167, v167
  v_exp_f32 v168, v168
  buffer_load_dwordx4 v[208:211], v237, s[16:19], s52 offen offset:1024 sc1
  v_exp_f32 v169, v169
  v_exp_f32 v170, v170
  v_exp_f32 v171, v171
  v_exp_f32 v140, v140
  v_exp_f32 v141, v141
  v_smfmac_f32_32x32x32_bf16 v[188:203], v[232:235], v[164:171], v236
  v_exp_f32 v142, v142
  v_exp_f32 v143, v143
  v_exp_f32 v144, v144
  v_mfma_f32_32x32x16_bf16 v[156:171], v[212:215], v[136:139], 4.0
  v_exp_f32 v145, v145
  v_exp_f32 v146, v146
  v_exp_f32 v147, v147
  v_exp_f32 v148, v148
  v_exp_f32 v149, v149
  s_waitcnt lgkmcnt(0)
  v_smfmac_f32_32x32x32_bf16 v[172:187], v[220:223], v[140:147], v236
  v_exp_f32 v150, v150
  v_exp_f32 v151, v151
  v_exp_f32 v152, v152
  s_mov_b64 exec, s[46:47]
  ds_read_b128 v[228:231], v239 offset:6144
  ds_read_b128 v[232:235], v239 offset:7168
  s_mov_b64 exec, -1
  v_exp_f32 v153, v153
  v_exp_f32 v154, v154
  v_exp_f32 v155, v155
  v_exp_f32 v156, v156
  v_exp_f32 v157, v157
  v_smfmac_f32_32x32x32_bf16 v[172:187], v[224:227], v[148:155], v236
  v_exp_f32 v158, v158
  v_exp_f32 v159, v159
  v_exp_f32 v160, v160
  s_waitcnt vmcnt(6)
  v_mfma_f32_32x32x16_bf16 v[140:155], v[216:219], v[132:135], 4.0
  v_exp_f32 v161, v161
  v_exp_f32 v162, v162
  v_exp_f32 v163, v163
  v_exp_f32 v164, v164
  v_exp_f32 v165, v165
  v_smfmac_f32_32x32x32_bf16 v[188:203], v[220:223], v[156:163], v236
  v_exp_f32 v166, v166
  v_exp_f32 v167, v167
  v_exp_f32 v168, v168
  buffer_load_dwordx4 v[212:215], v237, s[16:19], s52 offen offset:2048 sc1
  v_exp_f32 v169, v169
  v_exp_f32 v170, v170
  v_exp_f32 v171, v171
  v_exp_f32 v140, v140
  v_exp_f32 v141, v141
  v_smfmac_f32_32x32x32_bf16 v[188:203], v[224:227], v[164:171], v236
  v_exp_f32 v142, v142
  v_exp_f32 v143, v143
  v_exp_f32 v144, v144
  v_mfma_f32_32x32x16_bf16 v[156:171], v[216:219], v[136:139], 4.0
  v_exp_f32 v145, v145
  v_exp_f32 v146, v146
  v_exp_f32 v147, v147
  v_exp_f32 v148, v148
  v_exp_f32 v149, v149
  s_waitcnt lgkmcnt(0)
  v_smfmac_f32_32x32x32_bf16 v[172:187], v[228:231], v[140:147], v236
  v_exp_f32 v150, v150
  v_exp_f32 v151, v151
  v_exp_f32 v152, v152
  v_add_u32 v239, s53, v238
  s_mov_b64 exec, s[46:47]
  ds_read_b128 v[220:223], v239 offset:0
  ds_read_b128 v[224:227], v239 offset:1024
  s_mov_b64 exec, -1
  v_exp_f32 v153, v153
  v_exp_f32 v154, v154
  v_exp_f32 v155, v155
  v_exp_f32 v156, v156
  v_exp_f32 v157, v157
  v_smfmac_f32_32x32x32_bf16 v[172:187], v[232:235], v[148:155], v236
  v_exp_f32 v158, v158
  v_exp_f32 v159, v159
  v_exp_f32 v160, v160
  s_waitcnt vmcnt(6)
  v_mfma_f32_32x32x16_bf16 v[140:155], v[204:207], v[132:135], 4.0
  v_exp_f32 v161, v161
  v_exp_f32 v162, v162
  v_exp_f32 v163, v163
  v_exp_f32 v164, v164
  v_exp_f32 v165, v165
  v_smfmac_f32_32x32x32_bf16 v[188:203], v[228:231], v[156:163], v236
  v_exp_f32 v166, v166
  v_exp_f32 v167, v167
  v_exp_f32 v168, v168
  buffer_load_dwordx4 v[216:219], v237, s[16:19], s52 offen offset:3072 sc1
  v_exp_f32 v169, v169
  s_add_u32 s54, s54, 4096
  s_and_b32 s54, s54, 0xffff
  s_add_u32 s52, s54, s48
  s_lshl_b32 s53, s54, 1
  v_exp_f32 v170, v170
  v_exp_f32 v171, v171
  s_waitcnt vmcnt(3)
  ds_read_b64_tr_b16 v[20:21], v244 offset:0
  ds_read_b64_tr_b16 v[22:23], v244 offset:512
  ds_read_b64_tr_b16 v[24:25], v245 offset:0
  ds_read_b64_tr_b16 v[26:27], v245 offset:512
  v_exp_f32 v140, v140
  v_exp_f32 v141, v141
  v_smfmac_f32_32x32x32_bf16 v[188:203], v[232:235], v[164:171], v236
  v_exp_f32 v142, v142
  v_exp_f32 v143, v143
  v_exp_f32 v144, v144
  v_mfma_f32_32x32x16_bf16 v[156:171], v[204:207], v[136:139], 4.0
  v_exp_f32 v145, v145
  v_exp_f32 v146, v146
  ds_read_b64_tr_b16 v[28:29], v244 offset:2048
  ds_read_b64_tr_b16 v[30:31], v244 offset:2560
  ds_read_b64_tr_b16 v[32:33], v245 offset:2048
  ds_read_b64_tr_b16 v[34:35], v245 offset:2560
  v_exp_f32 v147, v147
  v_exp_f32 v148, v148
  v_exp_f32 v149, v149
  s_waitcnt lgkmcnt(0)
  v_smfmac_f32_32x32x32_bf16 v[172:187], v[220:223], v[140:147], v236
  v_exp_f32 v150, v150
  v_exp_f32 v151, v151
  v_exp_f32 v152, v152
  s_mov_b64 exec, s[46:47]
  ds_read_b128 v[228:231], v239 offset:2048
  ds_read_b128 v[232:235], v239 offset:3072
  s_mov_b64 exec, -1
  v_exp_f32 v153, v153
  v_exp_f32 v154, v154
  v_exp_f32 v155, v155
  v_exp_f32 v156, v156
  v_exp_f32 v157, v157
  v_smfmac_f32_32x32x32_bf16 v[172:187], v[224:227], v[148:155], v236
  v_exp_f32 v158, v158
  v_exp_f32 v159, v159
  v_exp_f32 v160, v160
  s_waitcnt vmcnt(2)
  v_mfma_f32_32x32x16_bf16 v[140:155], v[208:211], v[132:135], 4.0
  v_exp_f32 v161, v161
  v_exp_f32 v162, v162
  v_exp_f32 v163, v163
  v_exp_f32 v164, v164
  v_exp_f32 v165, v165
  v_smfmac_f32_32x32x32_bf16 v[188:203], v[220:223], v[156:163], v236
  v_exp_f32 v166, v166
  v_exp_f32 v167, v167
  v_exp_f32 v168, v168
  buffer_load_dwordx4 v[204:207], v237, s[16:19], s52 offen offset:0 sc1
  v_exp_f32 v169, v169
  v_exp_f32 v170, v170
  v_exp_f32 v171, v171
  s_mov_b32 m0, s6
  s_add_u32 s41, s7, 131072
  buffer_load_dwordx4 v243, s[12:15], s41 offen offset:0 lds
  s_add_u32 s41, s7, 146432
  buffer_load_dwordx4 v243, s[12:15], s41 offen offset:1024 lds
  s_add_u32 s41, s7, 161792
  buffer_load_dwordx4 v243, s[12:15], s41 offen offset:2048 lds
  s_add_u32 s41, s7, 177152
  buffer_load_dwordx4 v243, s[12:15], s41 offen offset:3072 lds
  v_exp_f32 v140, v140
  v_exp_f32 v141, v141
  v_smfmac_f32_32x32x32_bf16 v[188:203], v[224:227], v[164:171], v236
  v_exp_f32 v142, v142
  v_exp_f32 v143, v143
  v_exp_f32 v144, v144
  v_mfma_f32_32x32x16_bf16 v[156:171], v[208:211], v[136:139], 4.0
  v_exp_f32 v145, v145
  v_exp_f32 v146, v146
  v_exp_f32 v147, v147
  v_exp_f32 v148, v148
  v_exp_f32 v149, v149
  s_waitcnt lgkmcnt(0)
  v_smfmac_f32_32x32x32_bf16 v[172:187], v[228:231], v[140:147], v236
  v_exp_f32 v150, v150
  v_exp_f32 v151, v151
  v_exp_f32 v152, v152
  s_mov_b64 exec, s[46:47]
  ds_read_b128 v[220:223], v239 offset:4096
  ds_read_b128 v[224:227], v239 offset:5120
  s_mov_b64 exec, -1
  v_exp_f32 v153, v153
  v_exp_f32 v154, v154
  v_exp_f32 v155, v155
  v_exp_f32 v156, v156
  v_exp_f32 v157, v157
  v_smfmac_f32_32x32x32_bf16 v[172:187], v[232:235], v[148:155], v236
  v_exp_f32 v158, v158
  v_exp_f32 v159, v159
  v_exp_f32 v160, v160
  s_waitcnt vmcnt(6)
  v_mfma_f32_32x32x16_bf16 v[140:155], v[212:215], v[132:135], 4.0
  v_exp_f32 v161, v161
  v_exp_f32 v162, v162
  v_exp_f32 v163, v163
  v_exp_f32 v164, v164
  v_exp_f32 v165, v165
  v_smfmac_f32_32x32x32_bf16 v[188:203], v[228:231], v[156:163], v236
  v_exp_f32 v166, v166
  v_exp_f32 v167, v167
  v_exp_f32 v168, v168
  buffer_load_dwordx4 v[208:211], v237, s[16:19], s52 offen offset:1024 sc1
  v_exp_f32 v169, v169
  v_exp_f32 v170, v170
  v_exp_f32 v171, v171
  v_exp_f32 v140, v140
  v_exp_f32 v141, v141
  v_smfmac_f32_32x32x32_bf16 v[188:203], v[232:235], v[164:171], v236
  v_exp_f32 v142, v142
  v_exp_f32 v143, v143
  v_exp_f32 v144, v144
  v_mfma_f32_32x32x16_bf16 v[156:171], v[212:215], v[136:139], 4.0
  v_exp_f32 v145, v145
  v_exp_f32 v146, v146
  v_exp_f32 v147, v147
  v_exp_f32 v148, v148
  v_exp_f32 v149, v149
  s_waitcnt lgkmcnt(0)
  v_smfmac_f32_32x32x32_bf16 v[172:187], v[220:223], v[140:147], v236
  v_exp_f32 v150, v150
  v_exp_f32 v151, v151
  v_exp_f32 v152, v152
  s_mov_b64 exec, s[46:47]
  ds_read_b128 v[228:231], v239 offset:6144
  ds_read_b128 v[232:235], v239 offset:7168
  s_mov_b64 exec, -1
  v_exp_f32 v153, v153
  v_exp_f32 v154, v154
  v_exp_f32 v155, v155
  v_exp_f32 v156, v156
  v_exp_f32 v157, v157
  v_smfmac_f32_32x32x32_bf16 v[172:187], v[224:227], v[148:155], v236
  v_exp_f32 v158, v158
  v_exp_f32 v159, v159
  v_exp_f32 v160, v160
  s_waitcnt vmcnt(6)
  v_mfma_f32_32x32x16_bf16 v[140:155], v[216:219], v[132:135], 4.0
  v_exp_f32 v161, v161
  v_exp_f32 v162, v162
  v_exp_f32 v163, v163
  v_exp_f32 v164, v164
  v_exp_f32 v165, v165
  v_smfmac_f32_32x32x32_bf16 v[188:203], v[220:223], v[156:163], v236
  v_exp_f32 v166, v166
  v_exp_f32 v167, v167
  v_exp_f32 v168, v168
  buffer_load_dwordx4 v[212:215], v237, s[16:19], s52 offen offset:2048 sc1
  v_exp_f32 v169, v169
  v_exp_f32 v170, v170
  v_exp_f32 v171, v171
  v_exp_f32 v140, v140
  v_exp_f32 v141, v141
  v_smfmac_f32_32x32x32_bf16 v[188:203], v[224:227], v[164:171], v236
  v_exp_f32 v142, v142
  v_exp_f32 v143, v143
  v_exp_f32 v144, v144
  v_mfma_f32_32x32x16_bf16 v[156:171], v[216:219], v[136:139], 4.0
  v_exp_f32 v145, v145
  v_exp_f32 v146, v146
  v_exp_f32 v147, v147
  v_exp_f32 v148, v148
  v_exp_f32 v149, v149
  s_waitcnt lgkmcnt(0)
  v_smfmac_f32_32x32x32_bf16 v[172:187], v[228:231], v[140:147], v236
  v_exp_f32 v150, v150
  v_exp_f32 v151, v151
  v_exp_f32 v152, v152
  v_add_u32 v239, s53, v238
  s_mov_b64 exec, s[46:47]
  ds_read_b128 v[220:223], v239 offset:0
  ds_read_b128 v[224:227], v239 offset:1024
  s_mov_b64 exec, -1
  v_exp_f32 v153, v153
  v_exp_f32 v154, v154
  v_exp_f32 v155, v155
  v_exp_f32 v156, v156
  v_exp_f32 v157, v157
  v_smfmac_f32_32x32x32_bf16 v[172:187], v[232:235], v[148:155], v236
  v_exp_f32 v158, v158
  v_exp_f32 v159, v159
  v_exp_f32 v160, v160
  s_waitcnt vmcnt(6)
  v_mfma_f32_32x32x16_bf16 v[140:155], v[204:207], v[132:135], 4.0
  v_exp_f32 v161, v161
  v_exp_f32 v162, v162
  v_exp_f32 v163, v163
  v_exp_f32 v164, v164
  v_exp_f32 v165, v165
  v_smfmac_f32_32x32x32_bf16 v[188:203], v[228:231], v[156:163], v236
  v_exp_f32 v166, v166
  v_exp_f32 v167, v167
  v_exp_f32 v168, v168
  buffer_load_dwordx4 v[216:219], v237, s[16:19], s52 offen offset:3072 sc1
  v_exp_f32 v169, v169
  s_add_u32 s54, s54, 4096
  s_and_b32 s54, s54, 0xffff
  s_add_u32 s52, s54, s48
  s_lshl_b32 s53, s54, 1
  v_exp_f32 v170, v170
  v_exp_f32 v171, v171
  s_waitcnt vmcnt(3)
  ds_read_b64_tr_b16 v[36:37], v244 offset:0
  ds_read_b64_tr_b16 v[38:39], v244 offset:512
  ds_read_b64_tr_b16 v[40:41], v245 offset:0
  ds_read_b64_tr_b16 v[42:43], v245 offset:512
  v_exp_f32 v140, v140
  v_exp_f32 v141, v141
  v_smfmac_f32_32x32x32_bf16 v[188:203], v[232:235], v[164:171], v236
  v_exp_f32 v142, v142
  v_exp_f32 v143, v143
  v_exp_f32 v144, v144
  v_mfma_f32_32x32x16_bf16 v[156:171], v[204:207], v[136:139], 4.0
  v_exp_f32 v145, v145
  v_exp_f32 v146, v146
  ds_read_b64_tr_b16 v[44:45], v244 offset:2048
  ds_read_b64_tr_b16 v[46:47], v244 offset:2560
  ds_read_b64_tr_b16 v[48:49], v245 offset:2048
  ds_read_b64_tr_b16 v[50:51], v245 offset:2560
  v_exp_f32 v147, v147
  v_exp_f32 v148, v148
  v_exp_f32 v149, v149
  s_waitcnt lgkmcnt(0)
  v_smfmac_f32_32x32x32_bf16 v[172:187], v[220:223], v[140:147], v236
  v_exp_f32 v150, v150
  v_exp_f32 v151, v151
  v_exp_f32 v152, v152
  s_mov_b64 exec, s[46:47]
  ds_read_b128 v[228:231], v239 offset:2048
  ds_read_b128 v[232:235], v239 offset:3072
  s_mov_b64 exec, -1
  v_exp_f32 v153, v153
  v_exp_f32 v154, v154
  v_exp_f32 v155, v155
  v_exp_f32 v156, v156
  v_exp_f32 v157, v157
  v_smfmac_f32_32x32x32_bf16 v[172:187], v[224:227], v[148:155], v236
  v_exp_f32 v158, v158
  v_exp_f32 v159, v159
  v_exp_f32 v160, v160
  s_waitcnt vmcnt(2)
  v_mfma_f32_32x32x16_bf16 v[140:155], v[208:211], v[132:135], 4.0
  v_exp_f32 v161, v161
  v_exp_f32 v162, v162
  v_exp_f32 v163, v163
  v_exp_f32 v164, v164
  v_exp_f32 v165, v165
  v_smfmac_f32_32x32x32_bf16 v[188:203], v[220:223], v[156:163], v236
  v_exp_f32 v166, v166
  v_exp_f32 v167, v167
  v_exp_f32 v168, v168
  buffer_load_dwordx4 v[204:207], v237, s[16:19], s52 offen offset:0 sc1
  v_exp_f32 v169, v169
  v_exp_f32 v170, v170
  v_exp_f32 v171, v171
  s_mov_b32 m0, s6
  s_add_u32 s41, s7, 196608
  buffer_load_dwordx4 v243, s[12:15], s41 offen offset:0 lds
  s_add_u32 s41, s7, 211968
  buffer_load_dwordx4 v243, s[12:15], s41 offen offset:1024 lds
  s_add_u32 s41, s7, 227328
  buffer_load_dwordx4 v243, s[12:15], s41 offen offset:2048 lds
  s_add_u32 s41, s7, 242688
  buffer_load_dwordx4 v243, s[12:15], s41 offen offset:3072 lds
  v_exp_f32 v140, v140
  v_exp_f32 v141, v141
  v_smfmac_f32_32x32x32_bf16 v[188:203], v[224:227], v[164:171], v236
  v_exp_f32 v142, v142
  v_exp_f32 v143, v143
  v_exp_f32 v144, v144
  v_mfma_f32_32x32x16_bf16 v[156:171], v[208:211], v[136:139], 4.0
  v_exp_f32 v145, v145
  v_exp_f32 v146, v146
  v_exp_f32 v147, v147
  v_exp_f32 v148, v148
  v_exp_f32 v149, v149
  s_waitcnt lgkmcnt(0)
  v_smfmac_f32_32x32x32_bf16 v[172:187], v[228:231], v[140:147], v236
  v_exp_f32 v150, v150
  v_exp_f32 v151, v151
  v_exp_f32 v152, v152
  s_mov_b64 exec, s[46:47]
  ds_read_b128 v[220:223], v239 offset:4096
  ds_read_b128 v[224:227], v239 offset:5120
  s_mov_b64 exec, -1
  v_exp_f32 v153, v153
  v_exp_f32 v154, v154
  v_exp_f32 v155, v155
  v_exp_f32 v156, v156
  v_exp_f32 v157, v157
  v_smfmac_f32_32x32x32_bf16 v[172:187], v[232:235], v[148:155], v236
  v_exp_f32 v158, v158
  v_exp_f32 v159, v159
  v_exp_f32 v160, v160
  s_waitcnt vmcnt(6)
  v_mfma_f32_32x32x16_bf16 v[140:155], v[212:215], v[132:135], 4.0
  v_exp_f32 v161, v161
  v_exp_f32 v162, v162
  v_exp_f32 v163, v163
  v_exp_f32 v164, v164
  v_exp_f32 v165, v165
  v_smfmac_f32_32x32x32_bf16 v[188:203], v[228:231], v[156:163], v236
  v_exp_f32 v166, v166
  v_exp_f32 v167, v167
  v_exp_f32 v168, v168
  buffer_load_dwordx4 v[208:211], v237, s[16:19], s52 offen offset:1024 sc1
  v_exp_f32 v169, v169
  v_exp_f32 v170, v170
  v_exp_f32 v171, v171
  v_exp_f32 v140, v140
  v_exp_f32 v141, v141
  v_smfmac_f32_32x32x32_bf16 v[188:203], v[232:235], v[164:171], v236
  v_exp_f32 v142, v142
  v_exp_f32 v143, v143
  v_exp_f32 v144, v144
  v_mfma_f32_32x32x16_bf16 v[156:171], v[212:215], v[136:139], 4.0
  v_exp_f32 v145, v145
  v_exp_f32 v146, v146
  v_exp_f32 v147, v147
  v_exp_f32 v148, v148
  v_exp_f32 v149, v149
  s_waitcnt lgkmcnt(0)
  v_smfmac_f32_32x32x32_bf16 v[172:187], v[220:223], v[140:147], v236
  v_exp_f32 v150, v150
  v_exp_f32 v151, v151
  v_exp_f32 v152, v152
  s_mov_b64 exec, s[46:47]
  ds_read_b128 v[228:231], v239 offset:6144
  ds_read_b128 v[232:235], v239 offset:7168
  s_mov_b64 exec, -1
  v_exp_f32 v153, v153
  v_exp_f32 v154, v154
  v_exp_f32 v155, v155
  v_exp_f32 v156, v156
  v_exp_f32 v157, v157
  v_smfmac_f32_32x32x32_bf16 v[172:187], v[224:227], v[148:155], v236
  v_exp_f32 v158, v158
  v_exp_f32 v159, v159
  v_exp_f32 v160, v160
  s_waitcnt vmcnt(6)
  v_mfma_f32_32x32x16_bf16 v[140:155], v[216:219], v[132:135], 4.0
  v_exp_f32 v161, v161
  v_exp_f32 v162, v162
  v_exp_f32 v163, v163
  v_exp_f32 v164, v164
  v_exp_f32 v165, v165
  v_smfmac_f32_32x32x32_bf16 v[188:203], v[220:223], v[156:163], v236
  v_exp_f32 v166, v166
  v_exp_f32 v167, v167
  v_exp_f32 v168, v168
  buffer_load_dwordx4 v[212:215], v237, s[16:19], s52 offen offset:2048 sc1
  v_exp_f32 v169, v169
  v_exp_f32 v170, v170
  v_exp_f32 v171, v171
  v_exp_f32 v140, v140
  v_exp_f32 v141, v141
  v_smfmac_f32_32x32x32_bf16 v[188:203], v[224:227], v[164:171], v236
  v_exp_f32 v142, v142
  v_exp_f32 v143, v143
  v_exp_f32 v144, v144
  v_mfma_f32_32x32x16_bf16 v[156:171], v[216:219], v[136:139], 4.0
  v_exp_f32 v145, v145
  v_exp_f32 v146, v146
  v_exp_f32 v147, v147
  v_exp_f32 v148, v148
  v_exp_f32 v149, v149
  s_waitcnt lgkmcnt(0)
  v_smfmac_f32_32x32x32_bf16 v[172:187], v[228:231], v[140:147], v236
  v_exp_f32 v150, v150
  v_exp_f32 v151, v151
  v_exp_f32 v152, v152
  v_add_u32 v239, s53, v238
  s_mov_b64 exec, s[46:47]
  ds_read_b128 v[220:223], v239 offset:0
  ds_read_b128 v[224:227], v239 offset:1024
  s_mov_b64 exec, -1
  v_exp_f32 v153, v153
  v_exp_f32 v154, v154
  v_exp_f32 v155, v155
  v_exp_f32 v156, v156
  v_exp_f32 v157, v157
  v_smfmac_f32_32x32x32_bf16 v[172:187], v[232:235], v[148:155], v236
  v_exp_f32 v158, v158
  v_exp_f32 v159, v159
  v_exp_f32 v160, v160
  s_waitcnt vmcnt(6)
  v_mfma_f32_32x32x16_bf16 v[140:155], v[204:207], v[132:135], 4.0
  v_exp_f32 v161, v161
  v_exp_f32 v162, v162
  v_exp_f32 v163, v163
  v_exp_f32 v164, v164
  v_exp_f32 v165, v165
  v_smfmac_f32_32x32x32_bf16 v[188:203], v[228:231], v[156:163], v236
  v_exp_f32 v166, v166
  v_exp_f32 v167, v167
  v_exp_f32 v168, v168
  buffer_load_dwordx4 v[216:219], v237, s[16:19], s52 offen offset:3072 sc1
  v_exp_f32 v169, v169
  s_add_u32 s54, s54, 4096
  s_and_b32 s54, s54, 0xffff
  s_add_u32 s52, s54, s48
  s_lshl_b32 s53, s54, 1
  v_exp_f32 v170, v170
  v_exp_f32 v171, v171
  s_waitcnt vmcnt(3)
  ds_read_b64_tr_b16 v[52:53], v244 offset:0
  ds_read_b64_tr_b16 v[54:55], v244 offset:512
  ds_read_b64_tr_b16 v[56:57], v245 offset:0
  ds_read_b64_tr_b16 v[58:59], v245 offset:512
  v_exp_f32 v140, v140
  v_exp_f32 v141, v141
  v_smfmac_f32_32x32x32_bf16 v[188:203], v[232:235], v[164:171], v236
  v_exp_f32 v142, v142
  v_exp_f32 v143, v143
  v_exp_f32 v144, v144
  v_mfma_f32_32x32x16_bf16 v[156:171], v[204:207], v[136:139], 4.0
  v_exp_f32 v145, v145
  v_exp_f32 v146, v146
  ds_read_b64_tr_b16 v[60:61], v244 offset:2048
  ds_read_b64_tr_b16 v[62:63], v244 offset:2560
  ds_read_b64_tr_b16 v[64:65], v245 offset:2048
  ds_read_b64_tr_b16 v[66:67], v245 offset:2560
  v_exp_f32 v147, v147
  v_exp_f32 v148, v148
  v_exp_f32 v149, v149
  s_waitcnt lgkmcnt(0)
  v_smfmac_f32_32x32x32_bf16 v[172:187], v[220:223], v[140:147], v236
  v_exp_f32 v150, v150
  v_exp_f32 v151, v151
  v_exp_f32 v152, v152
  s_mov_b64 exec, s[46:47]
  ds_read_b128 v[228:231], v239 offset:2048
  ds_read_b128 v[232:235], v239 offset:3072
  s_mov_b64 exec, -1
  v_exp_f32 v153, v153
  v_exp_f32 v154, v154
  v_exp_f32 v155, v155
  v_exp_f32 v156, v156
  v_exp_f32 v157, v157
  v_smfmac_f32_32x32x32_bf16 v[172:187], v[224:227], v[148:155], v236
  v_exp_f32 v158, v158
  v_exp_f32 v159, v159
  v_exp_f32 v160, v160
  s_waitcnt vmcnt(2)
  v_mfma_f32_32x32x16_bf16 v[140:155], v[208:211], v[132:135], 4.0
  v_exp_f32 v161, v161
  v_exp_f32 v162, v162
  v_exp_f32 v163, v163
  v_exp_f32 v164, v164
  v_exp_f32 v165, v165
  v_smfmac_f32_32x32x32_bf16 v[188:203], v[220:223], v[156:163], v236
  v_exp_f32 v166, v166
  v_exp_f32 v167, v167
  v_exp_f32 v168, v168
  buffer_load_dwordx4 v[204:207], v237, s[16:19], s52 offen offset:0 sc1
  v_exp_f32 v169, v169
  v_exp_f32 v170, v170
  v_exp_f32 v171, v171
  s_mov_b32 m0, s6
  s_add_u32 s41, s7, 262144
  buffer_load_dwordx4 v243, s[12:15], s41 offen offset:0 lds
  s_add_u32 s41, s7, 277504
  buffer_load_dwordx4 v243, s[12:15], s41 offen offset:1024 lds
  s_add_u32 s41, s7, 292864
  buffer_load_dwordx4 v243, s[12:15], s41 offen offset:2048 lds
  s_add_u32 s41, s7, 308224
  buffer_load_dwordx4 v243, s[12:15], s41 offen offset:3072 lds
  v_exp_f32 v140, v140
  v_exp_f32 v141, v141
  v_smfmac_f32_32x32x32_bf16 v[188:203], v[224:227], v[164:171], v236
  v_exp_f32 v142, v142
  v_exp_f32 v143, v143
  v_exp_f32 v144, v144
  v_mfma_f32_32x32x16_bf16 v[156:171], v[208:211], v[136:139], 4.0
  v_exp_f32 v145, v145
  v_exp_f32 v146, v146
  v_exp_f32 v147, v147
  v_exp_f32 v148, v148
  v_exp_f32 v149, v149
  s_waitcnt lgkmcnt(0)
  v_smfmac_f32_32x32x32_bf16 v[172:187], v[228:231], v[140:147], v236
  v_exp_f32 v150, v150
  v_exp_f32 v151, v151
  v_exp_f32 v152, v152
  s_mov_b64 exec, s[46:47]
  ds_read_b128 v[220:223], v239 offset:4096
  ds_read_b128 v[224:227], v239 offset:5120
  s_mov_b64 exec, -1
  v_exp_f32 v153, v153
  v_exp_f32 v154, v154
  v_exp_f32 v155, v155
  v_exp_f32 v156, v156
  v_exp_f32 v157, v157
  v_smfmac_f32_32x32x32_bf16 v[172:187], v[232:235], v[148:155], v236
  v_exp_f32 v158, v158
  v_exp_f32 v159, v159
  v_exp_f32 v160, v160
  s_waitcnt vmcnt(6)
  v_mfma_f32_32x32x16_bf16 v[140:155], v[212:215], v[132:135], 4.0
  v_exp_f32 v161, v161
  v_exp_f32 v162, v162
  v_exp_f32 v163, v163
  v_exp_f32 v164, v164
  v_exp_f32 v165, v165
  v_smfmac_f32_32x32x32_bf16 v[188:203], v[228:231], v[156:163], v236
  v_exp_f32 v166, v166
  v_exp_f32 v167, v167
  v_exp_f32 v168, v168
  buffer_load_dwordx4 v[208:211], v237, s[16:19], s52 offen offset:1024 sc1
  v_exp_f32 v169, v169
  v_exp_f32 v170, v170
  v_exp_f32 v171, v171
  v_exp_f32 v140, v140
  v_exp_f32 v141, v141
  v_smfmac_f32_32x32x32_bf16 v[188:203], v[232:235], v[164:171], v236
  v_exp_f32 v142, v142
  v_exp_f32 v143, v143
  v_exp_f32 v144, v144
  v_mfma_f32_32x32x16_bf16 v[156:171], v[212:215], v[136:139], 4.0
  v_exp_f32 v145, v145
  v_exp_f32 v146, v146
  v_exp_f32 v147, v147
  v_exp_f32 v148, v148
  v_exp_f32 v149, v149
  s_waitcnt lgkmcnt(0)
  v_smfmac_f32_32x32x32_bf16 v[172:187], v[220:223], v[140:147], v236
  v_exp_f32 v150, v150
  v_exp_f32 v151, v151
  v_exp_f32 v152, v152
  s_mov_b64 exec, s[46:47]
  ds_read_b128 v[228:231], v239 offset:6144
  ds_read_b128 v[232:235], v239 offset:7168
  s_mov_b64 exec, -1
  v_exp_f32 v153, v153
  v_exp_f32 v154, v154
  v_exp_f32 v155, v155
  v_exp_f32 v156, v156
  v_exp_f32 v157, v157
  v_smfmac_f32_32x32x32_bf16 v[172:187], v[224:227], v[148:155], v236
  v_exp_f32 v158, v158
  v_exp_f32 v159, v159
  v_exp_f32 v160, v160
  s_waitcnt vmcnt(6)
  v_mfma_f32_32x32x16_bf16 v[140:155], v[216:219], v[132:135], 4.0
  v_exp_f32 v161, v161
  v_exp_f32 v162, v162
  v_exp_f32 v163, v163
  v_exp_f32 v164, v164
  v_exp_f32 v165, v165
  v_smfmac_f32_32x32x32_bf16 v[188:203], v[220:223], v[156:163], v236
  v_exp_f32 v166, v166
  v_exp_f32 v167, v167
  v_exp_f32 v168, v168
  buffer_load_dwordx4 v[212:215], v237, s[16:19], s52 offen offset:2048 sc1
  v_exp_f32 v169, v169
  v_exp_f32 v170, v170
  v_exp_f32 v171, v171
  v_exp_f32 v140, v140
  v_exp_f32 v141, v141
  v_smfmac_f32_32x32x32_bf16 v[188:203], v[224:227], v[164:171], v236
  v_exp_f32 v142, v142
  v_exp_f32 v143, v143
  v_exp_f32 v144, v144
  v_mfma_f32_32x32x16_bf16 v[156:171], v[216:219], v[136:139], 4.0
  v_exp_f32 v145, v145
  v_exp_f32 v146, v146
  v_exp_f32 v147, v147
  v_exp_f32 v148, v148
  v_exp_f32 v149, v149
  s_waitcnt lgkmcnt(0)
  v_smfmac_f32_32x32x32_bf16 v[172:187], v[228:231], v[140:147], v236
  v_exp_f32 v150, v150
  v_exp_f32 v151, v151
  v_exp_f32 v152, v152
  v_add_u32 v239, s53, v238
  s_mov_b64 exec, s[46:47]
  ds_read_b128 v[220:223], v239 offset:0
  ds_read_b128 v[224:227], v239 offset:1024
  s_mov_b64 exec, -1
  v_exp_f32 v153, v153
  v_exp_f32 v154, v154
  v_exp_f32 v155, v155
  v_exp_f32 v156, v156
  v_exp_f32 v157, v157
  v_smfmac_f32_32x32x32_bf16 v[172:187], v[232:235], v[148:155], v236
  v_exp_f32 v158, v158
  v_exp_f32 v159, v159
  v_exp_f32 v160, v160
  s_waitcnt vmcnt(6)
  v_mfma_f32_32x32x16_bf16 v[140:155], v[204:207], v[132:135], 4.0
  v_exp_f32 v161, v161
  v_exp_f32 v162, v162
  v_exp_f32 v163, v163
  v_exp_f32 v164, v164
  v_exp_f32 v165, v165
  v_smfmac_f32_32x32x32_bf16 v[188:203], v[228:231], v[156:163], v236
  v_exp_f32 v166, v166
  v_exp_f32 v167, v167
  v_exp_f32 v168, v168
  buffer_load_dwordx4 v[216:219], v237, s[16:19], s52 offen offset:3072 sc1
  v_exp_f32 v169, v169
  s_add_u32 s54, s54, 4096
  s_and_b32 s54, s54, 0xffff
  s_add_u32 s52, s54, s48
  s_lshl_b32 s53, s54, 1
  v_exp_f32 v170, v170
  v_exp_f32 v171, v171
  s_waitcnt vmcnt(3)
  ds_read_b64_tr_b16 v[68:69], v244 offset:0
  ds_read_b64_tr_b16 v[70:71], v244 offset:512
  ds_read_b64_tr_b16 v[72:73], v245 offset:0
  ds_read_b64_tr_b16 v[74:75], v245 offset:512
  v_exp_f32 v140, v140
  v_exp_f32 v141, v141
  v_smfmac_f32_32x32x32_bf16 v[188:203], v[232:235], v[164:171], v236
  v_exp_f32 v142, v142
  v_exp_f32 v143, v143
  v_exp_f32 v144, v144
  v_mfma_f32_32x32x16_bf16 v[156:171], v[204:207], v[136:139], 4.0
  v_exp_f32 v145, v145
  v_exp_f32 v146, v146
  ds_read_b64_tr_b16 v[76:77], v244 offset:2048
  ds_read_b64_tr_b16 v[78:79], v244 offset:2560
  ds_read_b64_tr_b16 v[80:81], v245 offset:2048
  ds_read_b64_tr_b16 v[82:83], v245 offset:2560
  v_exp_f32 v147, v147
  v_exp_f32 v148, v148
  v_exp_f32 v149, v149
  s_waitcnt lgkmcnt(0)
  v_smfmac_f32_32x32x32_bf16 v[172:187], v[220:223], v[140:147], v236
  v_exp_f32 v150, v150
  v_exp_f32 v151, v151
  v_exp_f32 v152, v152
  s_mov_b64 exec, s[46:47]
  ds_read_b128 v[228:231], v239 offset:2048
  ds_read_b128 v[232:235], v239 offset:3072
  s_mov_b64 exec, -1
  v_exp_f32 v153, v153
  v_exp_f32 v154, v154
  v_exp_f32 v155, v155
  v_exp_f32 v156, v156
  v_exp_f32 v157, v157
  v_smfmac_f32_32x32x32_bf16 v[172:187], v[224:227], v[148:155], v236
  v_exp_f32 v158, v158
  v_exp_f32 v159, v159
  v_exp_f32 v160, v160
  s_waitcnt vmcnt(2)
  v_mfma_f32_32x32x16_bf16 v[140:155], v[208:211], v[132:135], 4.0
  v_exp_f32 v161, v161
  v_exp_f32 v162, v162
  v_exp_f32 v163, v163
  v_exp_f32 v164, v164
  v_exp_f32 v165, v165
  v_smfmac_f32_32x32x32_bf16 v[188:203], v[220:223], v[156:163], v236
  v_exp_f32 v166, v166
  v_exp_f32 v167, v167
  v_exp_f32 v168, v168
  buffer_load_dwordx4 v[204:207], v237, s[16:19], s52 offen offset:0 sc1
  v_exp_f32 v169, v169
  v_exp_f32 v170, v170
  v_exp_f32 v171, v171
  s_mov_b32 m0, s6
  s_add_u32 s41, s7, 327680
  buffer_load_dwordx4 v243, s[12:15], s41 offen offset:0 lds
  s_add_u32 s41, s7, 343040
  buffer_load_dwordx4 v243, s[12:15], s41 offen offset:1024 lds
  s_add_u32 s41, s7, 358400
  buffer_load_dwordx4 v243, s[12:15], s41 offen offset:2048 lds
  s_add_u32 s41, s7, 373760
  buffer_load_dwordx4 v243, s[12:15], s41 offen offset:3072 lds
  v_exp_f32 v140, v140
  v_exp_f32 v141, v141
  v_smfmac_f32_32x32x32_bf16 v[188:203], v[224:227], v[164:171], v236
  v_exp_f32 v142, v142
  v_exp_f32 v143, v143
  v_exp_f32 v144, v144
  v_mfma_f32_32x32x16_bf16 v[156:171], v[208:211], v[136:139], 4.0
  v_exp_f32 v145, v145
  v_exp_f32 v146, v146
  v_exp_f32 v147, v147
  v_exp_f32 v148, v148
  v_exp_f32 v149, v149
  s_waitcnt lgkmcnt(0)
  v_smfmac_f32_32x32x32_bf16 v[172:187], v[228:231], v[140:147], v236
  v_exp_f32 v150, v150
  v_exp_f32 v151, v151
  v_exp_f32 v152, v152
  s_mov_b64 exec, s[46:47]
  ds_read_b128 v[220:223], v239 offset:4096
  ds_read_b128 v[224:227], v239 offset:5120
  s_mov_b64 exec, -1
  v_exp_f32 v153, v153
  v_exp_f32 v154, v154
  v_exp_f32 v155, v155
  v_exp_f32 v156, v156
  v_exp_f32 v157, v157
  v_smfmac_f32_32x32x32_bf16 v[172:187], v[232:235], v[148:155], v236
  v_exp_f32 v158, v158
  v_exp_f32 v159, v159
  v_exp_f32 v160, v160
  s_waitcnt vmcnt(6)
  v_mfma_f32_32x32x16_bf16 v[140:155], v[212:215], v[132:135], 4.0
  v_exp_f32 v161, v161
  v_exp_f32 v162, v162
  v_exp_f32 v163, v163
  v_exp_f32 v164, v164
  v_exp_f32 v165, v165
  v_smfmac_f32_32x32x32_bf16 v[188:203], v[228:231], v[156:163], v236
  v_exp_f32 v166, v166
  v_exp_f32 v167, v167
  v_exp_f32 v168, v168
  buffer_load_dwordx4 v[208:211], v237, s[16:19], s52 offen offset:1024 sc1
  v_exp_f32 v169, v169
  v_exp_f32 v170, v170
  v_exp_f32 v171, v171
  v_exp_f32 v140, v140
  v_exp_f32 v141, v141
  v_smfmac_f32_32x32x32_bf16 v[188:203], v[232:235], v[164:171], v236
  v_exp_f32 v142, v142
  v_exp_f32 v143, v143
  v_exp_f32 v144, v144
  v_mfma_f32_32x32x16_bf16 v[156:171], v[212:215], v[136:139], 4.0
  v_exp_f32 v145, v145
  v_exp_f32 v146, v146
  v_exp_f32 v147, v147
  v_exp_f32 v148, v148
  v_exp_f32 v149, v149
  s_waitcnt lgkmcnt(0)
  v_smfmac_f32_32x32x32_bf16 v[172:187], v[220:223], v[140:147], v236
  v_exp_f32 v150, v150
  v_exp_f32 v151, v151
  v_exp_f32 v152, v152
  s_mov_b64 exec, s[46:47]
  ds_read_b128 v[228:231], v239 offset:6144
  ds_read_b128 v[232:235], v239 offset:7168
  s_mov_b64 exec, -1
  v_exp_f32 v153, v153
  v_exp_f32 v154, v154
  v_exp_f32 v155, v155
  v_exp_f32 v156, v156
  v_exp_f32 v157, v157
  v_smfmac_f32_32x32x32_bf16 v[172:187], v[224:227], v[148:155], v236
  v_exp_f32 v158, v158
  v_exp_f32 v159, v159
  v_exp_f32 v160, v160
  s_waitcnt vmcnt(6)
  v_mfma_f32_32x32x16_bf16 v[140:155], v[216:219], v[132:135], 4.0
  v_exp_f32 v161, v161
  v_exp_f32 v162, v162
  v_exp_f32 v163, v163
  v_exp_f32 v164, v164
  v_exp_f32 v165, v165
  v_smfmac_f32_32x32x32_bf16 v[188:203], v[220:223], v[156:163], v236
  v_exp_f32 v166, v166
  v_exp_f32 v167, v167
  v_exp_f32 v168, v168
  buffer_load_dwordx4 v[212:215], v237, s[16:19], s52 offen offset:2048 sc1
  v_exp_f32 v169, v169
  v_exp_f32 v170, v170
  v_exp_f32 v171, v171
  v_exp_f32 v140, v140
  v_exp_f32 v141, v141
  v_smfmac_f32_32x32x32_bf16 v[188:203], v[224:227], v[164:171], v236
  v_exp_f32 v142, v142
  v_exp_f32 v143, v143
  v_exp_f32 v144, v144
  v_mfma_f32_32x32x16_bf16 v[156:171], v[216:219], v[136:139], 4.0
  v_exp_f32 v145, v145
  v_exp_f32 v146, v146
  v_exp_f32 v147, v147
  v_exp_f32 v148, v148
  v_exp_f32 v149, v149
  s_waitcnt lgkmcnt(0)
  v_smfmac_f32_32x32x32_bf16 v[172:187], v[228:231], v[140:147], v236
  v_exp_f32 v150, v150
  v_exp_f32 v151, v151
  v_exp_f32 v152, v152
  v_add_u32 v239, s53, v238
  s_mov_b64 exec, s[46:47]
  ds_read_b128 v[220:223], v239 offset:0
  ds_read_b128 v[224:227], v239 offset:1024
  s_mov_b64 exec, -1
  v_exp_f32 v153, v153
  v_exp_f32 v154, v154
  v_exp_f32 v155, v155
  v_exp_f32 v156, v156
  v_exp_f32 v157, v157
  v_smfmac_f32_32x32x32_bf16 v[172:187], v[232:235], v[148:155], v236
  v_exp_f32 v158, v158
  v_exp_f32 v159, v159
  v_exp_f32 v160, v160
  s_waitcnt vmcnt(6)
  v_mfma_f32_32x32x16_bf16 v[140:155], v[204:207], v[132:135], 4.0
  v_exp_f32 v161, v161
  v_exp_f32 v162, v162
  v_exp_f32 v163, v163
  v_exp_f32 v164, v164
  v_exp_f32 v165, v165
  v_smfmac_f32_32x32x32_bf16 v[188:203], v[228:231], v[156:163], v236
  v_exp_f32 v166, v166
  v_exp_f32 v167, v167
  v_exp_f32 v168, v168
  buffer_load_dwordx4 v[216:219], v237, s[16:19], s52 offen offset:3072 sc1
  v_exp_f32 v169, v169
  s_add_u32 s54, s54, 4096
  s_and_b32 s54, s54, 0xffff
  s_add_u32 s52, s54, s48
  s_lshl_b32 s53, s54, 1
  v_exp_f32 v170, v170
  v_exp_f32 v171, v171
  s_waitcnt vmcnt(3)
  ds_read_b64_tr_b16 v[84:85], v244 offset:0
  ds_read_b64_tr_b16 v[86:87], v244 offset:512
  ds_read_b64_tr_b16 v[88:89], v245 offset:0
  ds_read_b64_tr_b16 v[90:91], v245 offset:512
  v_exp_f32 v140, v140
  v_exp_f32 v141, v141
  v_smfmac_f32_32x32x32_bf16 v[188:203], v[232:235], v[164:171], v236
  v_exp_f32 v142, v142
  v_exp_f32 v143, v143
  v_exp_f32 v144, v144
  v_mfma_f32_32x32x16_bf16 v[156:171], v[204:207], v[136:139], 4.0
  v_exp_f32 v145, v145
  v_exp_f32 v146, v146
  ds_read_b64_tr_b16 v[92:93], v244 offset:2048
  ds_read_b64_tr_b16 v[94:95], v244 offset:2560
  ds_read_b64_tr_b16 v[96:97], v245 offset:2048
  ds_read_b64_tr_b16 v[98:99], v245 offset:2560
  v_exp_f32 v147, v147
  v_exp_f32 v148, v148
  v_exp_f32 v149, v149
  s_waitcnt lgkmcnt(0)
  v_smfmac_f32_32x32x32_bf16 v[172:187], v[220:223], v[140:147], v236
  v_exp_f32 v150, v150
  v_exp_f32 v151, v151
  v_exp_f32 v152, v152
  s_mov_b64 exec, s[46:47]
  ds_read_b128 v[228:231], v239 offset:2048
  ds_read_b128 v[232:235], v239 offset:3072
  s_mov_b64 exec, -1
  v_exp_f32 v153, v153
  v_exp_f32 v154, v154
  v_exp_f32 v155, v155
  v_exp_f32 v156, v156
  v_exp_f32 v157, v157
  v_smfmac_f32_32x32x32_bf16 v[172:187], v[224:227], v[148:155], v236
  v_exp_f32 v158, v158
  v_exp_f32 v159, v159
  v_exp_f32 v160, v160
  s_waitcnt vmcnt(2)
  v_mfma_f32_32x32x16_bf16 v[140:155], v[208:211], v[132:135], 4.0
  v_exp_f32 v161, v161
  v_exp_f32 v162, v162
  v_exp_f32 v163, v163
  v_exp_f32 v164, v164
  v_exp_f32 v165, v165
  v_smfmac_f32_32x32x32_bf16 v[188:203], v[220:223], v[156:163], v236
  v_exp_f32 v166, v166
  v_exp_f32 v167, v167
  v_exp_f32 v168, v168
  buffer_load_dwordx4 v[204:207], v237, s[16:19], s52 offen offset:0 sc1
  v_exp_f32 v169, v169
  v_exp_f32 v170, v170
  v_exp_f32 v171, v171
  s_mov_b32 m0, s6
  s_add_u32 s41, s7, 393216
  buffer_load_dwordx4 v243, s[12:15], s41 offen offset:0 lds
  s_add_u32 s41, s7, 408576
  buffer_load_dwordx4 v243, s[12:15], s41 offen offset:1024 lds
  s_add_u32 s41, s7, 423936
  buffer_load_dwordx4 v243, s[12:15], s41 offen offset:2048 lds
  s_add_u32 s41, s7, 439296
  buffer_load_dwordx4 v243, s[12:15], s41 offen offset:3072 lds
  v_exp_f32 v140, v140
  v_exp_f32 v141, v141
  v_smfmac_f32_32x32x32_bf16 v[188:203], v[224:227], v[164:171], v236
  v_exp_f32 v142, v142
  v_exp_f32 v143, v143
  v_exp_f32 v144, v144
  v_mfma_f32_32x32x16_bf16 v[156:171], v[208:211], v[136:139], 4.0
  v_exp_f32 v145, v145
  v_exp_f32 v146, v146
  v_exp_f32 v147, v147
  v_exp_f32 v148, v148
  v_exp_f32 v149, v149
  s_waitcnt lgkmcnt(0)
  v_smfmac_f32_32x32x32_bf16 v[172:187], v[228:231], v[140:147], v236
  v_exp_f32 v150, v150
  v_exp_f32 v151, v151
  v_exp_f32 v152, v152
  s_mov_b64 exec, s[46:47]
  ds_read_b128 v[220:223], v239 offset:4096
  ds_read_b128 v[224:227], v239 offset:5120
  s_mov_b64 exec, -1
  v_exp_f32 v153, v153
  v_exp_f32 v154, v154
  v_exp_f32 v155, v155
  v_exp_f32 v156, v156
  v_exp_f32 v157, v157
  v_smfmac_f32_32x32x32_bf16 v[172:187], v[232:235], v[148:155], v236
  v_exp_f32 v158, v158
  v_exp_f32 v159, v159
  v_exp_f32 v160, v160
  s_waitcnt vmcnt(6)
  v_mfma_f32_32x32x16_bf16 v[140:155], v[212:215], v[132:135], 4.0
  v_exp_f32 v161, v161
  v_exp_f32 v162, v162
  v_exp_f32 v163, v163
  v_exp_f32 v164, v164
  v_exp_f32 v165, v165
  v_smfmac_f32_32x32x32_bf16 v[188:203], v[228:231], v[156:163], v236
  v_exp_f32 v166, v166
  v_exp_f32 v167, v167
  v_exp_f32 v168, v168
  buffer_load_dwordx4 v[208:211], v237, s[16:19], s52 offen offset:1024 sc1
  v_exp_f32 v169, v169
  v_exp_f32 v170, v170
  v_exp_f32 v171, v171
  v_exp_f32 v140, v140
  v_exp_f32 v141, v141
  v_smfmac_f32_32x32x32_bf16 v[188:203], v[232:235], v[164:171], v236
  v_exp_f32 v142, v142
  v_exp_f32 v143, v143
  v_exp_f32 v144, v144
  v_mfma_f32_32x32x16_bf16 v[156:171], v[212:215], v[136:139], 4.0
  v_exp_f32 v145, v145
  v_exp_f32 v146, v146
  v_exp_f32 v147, v147
  v_exp_f32 v148, v148
  v_exp_f32 v149, v149
  s_waitcnt lgkmcnt(0)
  v_smfmac_f32_32x32x32_bf16 v[172:187], v[220:223], v[140:147], v236
  v_exp_f32 v150, v150
  v_exp_f32 v151, v151
  v_exp_f32 v152, v152
  s_mov_b64 exec, s[46:47]
  ds_read_b128 v[228:231], v239 offset:6144
  ds_read_b128 v[232:235], v239 offset:7168
  s_mov_b64 exec, -1
  v_exp_f32 v153, v153
  v_exp_f32 v154, v154
  v_exp_f32 v155, v155
  v_exp_f32 v156, v156
  v_exp_f32 v157, v157
  v_smfmac_f32_32x32x32_bf16 v[172:187], v[224:227], v[148:155], v236
  v_exp_f32 v158, v158
  v_exp_f32 v159, v159
  v_exp_f32 v160, v160
  s_waitcnt vmcnt(6)
  v_mfma_f32_32x32x16_bf16 v[140:155], v[216:219], v[132:135], 4.0
  v_exp_f32 v161, v161
  v_exp_f32 v162, v162
  v_exp_f32 v163, v163
  v_exp_f32 v164, v164
  v_exp_f32 v165, v165
  v_smfmac_f32_32x32x32_bf16 v[188:203], v[220:223], v[156:163], v236
  v_exp_f32 v166, v166
  v_exp_f32 v167, v167
  v_exp_f32 v168, v168
  buffer_load_dwordx4 v[212:215], v237, s[16:19], s52 offen offset:2048 sc1
  v_exp_f32 v169, v169
  v_exp_f32 v170, v170
  v_exp_f32 v171, v171
  v_exp_f32 v140, v140
  v_exp_f32 v141, v141
  v_smfmac_f32_32x32x32_bf16 v[188:203], v[224:227], v[164:171], v236
  v_exp_f32 v142, v142
  v_exp_f32 v143, v143
  v_exp_f32 v144, v144
  v_mfma_f32_32x32x16_bf16 v[156:171], v[216:219], v[136:139], 4.0
  v_exp_f32 v145, v145
  v_exp_f32 v146, v146
  v_exp_f32 v147, v147
  v_exp_f32 v148, v148
  v_exp_f32 v149, v149
  s_waitcnt lgkmcnt(0)
  v_smfmac_f32_32x32x32_bf16 v[172:187], v[228:231], v[140:147], v236
  v_exp_f32 v150, v150
  v_exp_f32 v151, v151
  v_exp_f32 v152, v152
  v_add_u32 v239, s53, v238
  s_mov_b64 exec, s[46:47]
  ds_read_b128 v[220:223], v239 offset:0
  ds_read_b128 v[224:227], v239 offset:1024
  s_mov_b64 exec, -1
  v_exp_f32 v153, v153
  v_exp_f32 v154, v154
  v_exp_f32 v155, v155
  v_exp_f32 v156, v156
  v_exp_f32 v157, v157
  v_smfmac_f32_32x32x32_bf16 v[172:187], v[232:235], v[148:155], v236
  v_exp_f32 v158, v158
  v_exp_f32 v159, v159
  v_exp_f32 v160, v160
  s_waitcnt vmcnt(6)
  v_mfma_f32_32x32x16_bf16 v[140:155], v[204:207], v[132:135], 4.0
  v_exp_f32 v161, v161
  v_exp_f32 v162, v162
  v_exp_f32 v163, v163
  v_exp_f32 v164, v164
  v_exp_f32 v165, v165
  v_smfmac_f32_32x32x32_bf16 v[188:203], v[228:231], v[156:163], v236
  v_exp_f32 v166, v166
  v_exp_f32 v167, v167
  v_exp_f32 v168, v168
  buffer_load_dwordx4 v[216:219], v237, s[16:19], s52 offen offset:3072 sc1
  v_exp_f32 v169, v169
  s_add_u32 s54, s54, 4096
  s_and_b32 s54, s54, 0xffff
  s_add_u32 s52, s54, s48
  s_lshl_b32 s53, s54, 1
  v_exp_f32 v170, v170
  v_exp_f32 v171, v171
  s_waitcnt vmcnt(3)
  ds_read_b64_tr_b16 v[100:101], v244 offset:0
  ds_read_b64_tr_b16 v[102:103], v244 offset:512
  ds_read_b64_tr_b16 v[104:105], v245 offset:0
  ds_read_b64_tr_b16 v[106:107], v245 offset:512
  v_exp_f32 v140, v140
  v_exp_f32 v141, v141
  v_smfmac_f32_32x32x32_bf16 v[188:203], v[232:235], v[164:171], v236
  v_exp_f32 v142, v142
  v_exp_f32 v143, v143
  v_exp_f32 v144, v144
  v_mfma_f32_32x32x16_bf16 v[156:171], v[204:207], v[136:139], 4.0
  v_exp_f32 v145, v145
  v_exp_f32 v146, v146
  ds_read_b64_tr_b16 v[108:109], v244 offset:2048
  ds_read_b64_tr_b16 v[110:111], v244 offset:2560
  ds_read_b64_tr_b16 v[112:113], v245 offset:2048
  ds_read_b64_tr_b16 v[114:115], v245 offset:2560
  v_exp_f32 v147, v147
  v_exp_f32 v148, v148
  v_exp_f32 v149, v149
  s_waitcnt lgkmcnt(0)
  v_smfmac_f32_32x32x32_bf16 v[172:187], v[220:223], v[140:147], v236
  v_exp_f32 v150, v150
  v_exp_f32 v151, v151
  v_exp_f32 v152, v152
  s_mov_b64 exec, s[46:47]
  ds_read_b128 v[228:231], v239 offset:2048
  ds_read_b128 v[232:235], v239 offset:3072
  s_mov_b64 exec, -1
  v_exp_f32 v153, v153
  v_exp_f32 v154, v154
  v_exp_f32 v155, v155
  v_exp_f32 v156, v156
  v_exp_f32 v157, v157
  v_smfmac_f32_32x32x32_bf16 v[172:187], v[224:227], v[148:155], v236
  v_exp_f32 v158, v158
  v_exp_f32 v159, v159
  v_exp_f32 v160, v160
  s_waitcnt vmcnt(2)
  v_mfma_f32_32x32x16_bf16 v[140:155], v[208:211], v[132:135], 4.0
  v_exp_f32 v161, v161
  v_exp_f32 v162, v162
  v_exp_f32 v163, v163
  v_exp_f32 v164, v164
  v_exp_f32 v165, v165
  v_smfmac_f32_32x32x32_bf16 v[188:203], v[220:223], v[156:163], v236
  v_exp_f32 v166, v166
  v_exp_f32 v167, v167
  v_exp_f32 v168, v168
  buffer_load_dwordx4 v[204:207], v237, s[16:19], s52 offen offset:0 sc1
  v_exp_f32 v169, v169
  v_exp_f32 v170, v170
  v_exp_f32 v171, v171
  s_mov_b32 m0, s6
  s_add_u32 s41, s7, 458752
  buffer_load_dwordx4 v243, s[12:15], s41 offen offset:0 lds
  s_add_u32 s41, s7, 474112
  buffer_load_dwordx4 v243, s[12:15], s41 offen offset:1024 lds
  s_add_u32 s41, s7, 489472
  buffer_load_dwordx4 v243, s[12:15], s41 offen offset:2048 lds
  s_add_u32 s41, s7, 504832
  buffer_load_dwordx4 v243, s[12:15], s41 offen offset:3072 lds
  v_exp_f32 v140, v140
  v_exp_f32 v141, v141
  v_smfmac_f32_32x32x32_bf16 v[188:203], v[224:227], v[164:171], v236
  v_exp_f32 v142, v142
  v_exp_f32 v143, v143
  v_exp_f32 v144, v144
  v_mfma_f32_32x32x16_bf16 v[156:171], v[208:211], v[136:139], 4.0
  v_exp_f32 v145, v145
  v_exp_f32 v146, v146
  v_exp_f32 v147, v147
  v_exp_f32 v148, v148
  v_exp_f32 v149, v149
  s_waitcnt lgkmcnt(0)
  v_smfmac_f32_32x32x32_bf16 v[172:187], v[228:231], v[140:147], v236
  v_exp_f32 v150, v150
  v_exp_f32 v151, v151
  v_exp_f32 v152, v152
  s_mov_b64 exec, s[46:47]
  ds_read_b128 v[220:223], v239 offset:4096
  ds_read_b128 v[224:227], v239 offset:5120
  s_mov_b64 exec, -1
  v_exp_f32 v153, v153
  v_exp_f32 v154, v154
  v_exp_f32 v155, v155
  v_exp_f32 v156, v156
  v_exp_f32 v157, v157
  v_smfmac_f32_32x32x32_bf16 v[172:187], v[232:235], v[148:155], v236
  v_exp_f32 v158, v158
  v_exp_f32 v159, v159
  v_exp_f32 v160, v160
  s_waitcnt vmcnt(6)
  v_mfma_f32_32x32x16_bf16 v[140:155], v[212:215], v[132:135], 4.0
  v_exp_f32 v161, v161
  v_exp_f32 v162, v162
  v_exp_f32 v163, v163
  v_exp_f32 v164, v164
  v_exp_f32 v165, v165
  v_smfmac_f32_32x32x32_bf16 v[188:203], v[228:231], v[156:163], v236
  v_exp_f32 v166, v166
  v_exp_f32 v167, v167
  v_exp_f32 v168, v168
  buffer_load_dwordx4 v[208:211], v237, s[16:19], s52 offen offset:1024 sc1
  v_exp_f32 v169, v169
  v_exp_f32 v170, v170
  v_exp_f32 v171, v171
  v_exp_f32 v140, v140
  v_exp_f32 v141, v141
  v_smfmac_f32_32x32x32_bf16 v[188:203], v[232:235], v[164:171], v236
  v_exp_f32 v142, v142
  v_exp_f32 v143, v143
  v_exp_f32 v144, v144
  v_mfma_f32_32x32x16_bf16 v[156:171], v[212:215], v[136:139], 4.0
  v_exp_f32 v145, v145
  v_exp_f32 v146, v146
  v_exp_f32 v147, v147
  v_exp_f32 v148, v148
  v_exp_f32 v149, v149
  s_waitcnt lgkmcnt(0)
  v_smfmac_f32_32x32x32_bf16 v[172:187], v[220:223], v[140:147], v236
  v_exp_f32 v150, v150
  v_exp_f32 v151, v151
  v_exp_f32 v152, v152
  s_mov_b64 exec, s[46:47]
  ds_read_b128 v[228:231], v239 offset:6144
  ds_read_b128 v[232:235], v239 offset:7168
  s_mov_b64 exec, -1
  v_exp_f32 v153, v153
  v_exp_f32 v154, v154
  v_exp_f32 v155, v155
  v_exp_f32 v156, v156
  v_exp_f32 v157, v157
  v_smfmac_f32_32x32x32_bf16 v[172:187], v[224:227], v[148:155], v236
  v_exp_f32 v158, v158
  v_exp_f32 v159, v159
  v_exp_f32 v160, v160
  s_waitcnt vmcnt(6)
  v_mfma_f32_32x32x16_bf16 v[140:155], v[216:219], v[132:135], 4.0
  v_exp_f32 v161, v161
  v_exp_f32 v162, v162
  v_exp_f32 v163, v163
  v_exp_f32 v164, v164
  v_exp_f32 v165, v165
  v_smfmac_f32_32x32x32_bf16 v[188:203], v[220:223], v[156:163], v236
  v_exp_f32 v166, v166
  v_exp_f32 v167, v167
  v_exp_f32 v168, v168
  buffer_load_dwordx4 v[212:215], v237, s[16:19], s52 offen offset:2048 sc1
  v_exp_f32 v169, v169
  v_exp_f32 v170, v170
  v_exp_f32 v171, v171
  v_exp_f32 v140, v140
  v_exp_f32 v141, v141
  v_smfmac_f32_32x32x32_bf16 v[188:203], v[224:227], v[164:171], v236
  v_exp_f32 v142, v142
  v_exp_f32 v143, v143
  v_exp_f32 v144, v144
  v_mfma_f32_32x32x16_bf16 v[156:171], v[216:219], v[136:139], 4.0
  v_exp_f32 v145, v145
  v_exp_f32 v146, v146
  v_exp_f32 v147, v147
  v_exp_f32 v148, v148
  v_exp_f32 v149, v149
  s_waitcnt lgkmcnt(0)
  v_smfmac_f32_32x32x32_bf16 v[172:187], v[228:231], v[140:147], v236
  v_exp_f32 v150, v150
  v_exp_f32 v151, v151
  v_exp_f32 v152, v152
  v_add_u32 v239, s53, v238
  s_mov_b64 exec, s[46:47]
  ds_read_b128 v[220:223], v239 offset:0
  ds_read_b128 v[224:227], v239 offset:1024
  s_mov_b64 exec, -1
  v_exp_f32 v153, v153
  v_exp_f32 v154, v154
  v_exp_f32 v155, v155
  v_exp_f32 v156, v156
  v_exp_f32 v157, v157
  v_smfmac_f32_32x32x32_bf16 v[172:187], v[232:235], v[148:155], v236
  v_exp_f32 v158, v158
  v_exp_f32 v159, v159
  v_exp_f32 v160, v160
  s_waitcnt vmcnt(6)
  v_mfma_f32_32x32x16_bf16 v[140:155], v[204:207], v[132:135], 4.0
  v_exp_f32 v161, v161
  v_exp_f32 v162, v162
  v_exp_f32 v163, v163
  v_exp_f32 v164, v164
  v_exp_f32 v165, v165
  v_smfmac_f32_32x32x32_bf16 v[188:203], v[228:231], v[156:163], v236
  v_exp_f32 v166, v166
  v_exp_f32 v167, v167
  v_exp_f32 v168, v168
  buffer_load_dwordx4 v[216:219], v237, s[16:19], s52 offen offset:3072 sc1
  v_exp_f32 v169, v169
  s_add_u32 s54, s54, 4096
  s_and_b32 s54, s54, 0xffff
  s_add_u32 s52, s54, s48
  s_lshl_b32 s53, s54, 1
  v_exp_f32 v170, v170
  v_exp_f32 v171, v171
  s_waitcnt vmcnt(3)
  ds_read_b64_tr_b16 v[116:117], v244 offset:0
  ds_read_b64_tr_b16 v[118:119], v244 offset:512
  ds_read_b64_tr_b16 v[120:121], v245 offset:0
  ds_read_b64_tr_b16 v[122:123], v245 offset:512
  v_exp_f32 v140, v140
  v_exp_f32 v141, v141
  v_smfmac_f32_32x32x32_bf16 v[188:203], v[232:235], v[164:171], v236
  v_exp_f32 v142, v142
  v_exp_f32 v143, v143
  v_exp_f32 v144, v144
  v_mfma_f32_32x32x16_bf16 v[156:171], v[204:207], v[136:139], 4.0
  v_exp_f32 v145, v145
  v_exp_f32 v146, v146
  ds_read_b64_tr_b16 v[124:125], v244 offset:2048
  ds_read_b64_tr_b16 v[126:127], v244 offset:2560
  ds_read_b64_tr_b16 v[128:129], v245 offset:2048
  ds_read_b64_tr_b16 v[130:131], v245 offset:2560
  v_exp_f32 v147, v147
  v_exp_f32 v148, v148
  v_exp_f32 v149, v149
  s_waitcnt lgkmcnt(0)
  v_smfmac_f32_32x32x32_bf16 v[172:187], v[220:223], v[140:147], v236
  v_exp_f32 v150, v150
  v_exp_f32 v151, v151
  v_exp_f32 v152, v152
  s_mov_b64 exec, s[46:47]
  ds_read_b128 v[228:231], v239 offset:2048
  ds_read_b128 v[232:235], v239 offset:3072
  s_mov_b64 exec, -1
  v_exp_f32 v153, v153
  v_exp_f32 v154, v154
  v_exp_f32 v155, v155
  s_setprio 0
  v_exp_f32 v156, v156
  v_exp_f32 v157, v157
  v_smfmac_f32_32x32x32_bf16 v[172:187], v[224:227], v[148:155], v236
  v_exp_f32 v158, v158
  v_exp_f32 v159, v159
  v_exp_f32 v160, v160
  s_waitcnt vmcnt(2)
  v_mfma_f32_32x32x16_bf16 v[140:155], v[208:211], v[132:135], 4.0
  v_exp_f32 v161, v161
  v_exp_f32 v162, v162
  v_exp_f32 v163, v163
  v_exp_f32 v164, v164
  v_exp_f32 v165, v165
  v_smfmac_f32_32x32x32_bf16 v[188:203], v[220:223], v[156:163], v236
  v_exp_f32 v166, v166
  v_exp_f32 v167, v167
  v_exp_f32 v168, v168
  buffer_load_dwordx4 v[204:207], v237, s[16:19], s52 offen offset:0 sc1
  v_exp_f32 v169, v169
  v_exp_f32 v170, v170
  v_exp_f32 v171, v171
  v_exp_f32 v140, v140
  v_exp_f32 v141, v141
  v_smfmac_f32_32x32x32_bf16 v[188:203], v[224:227], v[164:171], v236
  v_exp_f32 v142, v142
  v_exp_f32 v143, v143
  v_exp_f32 v144, v144
  v_mfma_f32_32x32x16_bf16 v[156:171], v[208:211], v[136:139], 4.0
  v_exp_f32 v145, v145
  v_exp_f32 v146, v146
  v_exp_f32 v147, v147
  v_exp_f32 v148, v148
  v_exp_f32 v149, v149
  s_waitcnt lgkmcnt(0)
  v_smfmac_f32_32x32x32_bf16 v[172:187], v[228:231], v[140:147], v236
  v_exp_f32 v150, v150
  v_exp_f32 v151, v151
  v_exp_f32 v152, v152
  s_mov_b64 exec, s[46:47]
  ds_read_b128 v[220:223], v239 offset:4096
  ds_read_b128 v[224:227], v239 offset:5120
  s_mov_b64 exec, -1
  v_exp_f32 v153, v153
  v_exp_f32 v154, v154
  v_exp_f32 v155, v155
  v_exp_f32 v156, v156
  v_exp_f32 v157, v157
  v_smfmac_f32_32x32x32_bf16 v[172:187], v[232:235], v[148:155], v236
  v_exp_f32 v158, v158
  v_exp_f32 v159, v159
  v_exp_f32 v160, v160
  s_waitcnt vmcnt(2)
  v_mfma_f32_32x32x16_bf16 v[140:155], v[212:215], v[132:135], 4.0
  v_exp_f32 v161, v161
  v_exp_f32 v162, v162
  v_exp_f32 v163, v163
  v_exp_f32 v164, v164
  v_exp_f32 v165, v165
  v_smfmac_f32_32x32x32_bf16 v[188:203], v[228:231], v[156:163], v236
  v_exp_f32 v166, v166
  v_exp_f32 v167, v167
  v_exp_f32 v168, v168
  buffer_load_dwordx4 v[208:211], v237, s[16:19], s52 offen offset:1024 sc1
  v_exp_f32 v169, v169
  v_exp_f32 v170, v170
  v_exp_f32 v171, v171
  v_exp_f32 v140, v140
  v_exp_f32 v141, v141
  v_smfmac_f32_32x32x32_bf16 v[188:203], v[232:235], v[164:171], v236
  v_exp_f32 v142, v142
  v_exp_f32 v143, v143
  v_exp_f32 v144, v144
  v_mfma_f32_32x32x16_bf16 v[156:171], v[212:215], v[136:139], 4.0
  v_exp_f32 v145, v145
  v_exp_f32 v146, v146
  v_exp_f32 v147, v147
  v_exp_f32 v148, v148
  v_exp_f32 v149, v149
  s_waitcnt lgkmcnt(0)
  v_smfmac_f32_32x32x32_bf16 v[172:187], v[220:223], v[140:147], v236
  v_exp_f32 v150, v150
  v_exp_f32 v151, v151
  v_exp_f32 v152, v152
  s_mov_b64 exec, s[46:47]
  ds_read_b128 v[228:231], v239 offset:6144
  ds_read_b128 v[232:235], v239 offset:7168
  s_mov_b64 exec, -1
  v_exp_f32 v153, v153
  v_exp_f32 v154, v154
  v_exp_f32 v155, v155
  v_exp_f32 v156, v156
  v_exp_f32 v157, v157
  v_smfmac_f32_32x32x32_bf16 v[172:187], v[224:227], v[148:155], v236
  v_exp_f32 v158, v158
  v_exp_f32 v159, v159
  v_exp_f32 v160, v160
  s_waitcnt vmcnt(2)
  v_mfma_f32_32x32x16_bf16 v[140:155], v[216:219], v[132:135], 4.0
  v_exp_f32 v161, v161
  v_exp_f32 v162, v162
  v_exp_f32 v163, v163
  v_exp_f32 v164, v164
  v_exp_f32 v165, v165
  v_smfmac_f32_32x32x32_bf16 v[188:203], v[220:223], v[156:163], v236
  v_exp_f32 v166, v166
  v_exp_f32 v167, v167
  v_exp_f32 v168, v168
  buffer_load_dwordx4 v[212:215], v237, s[16:19], s52 offen offset:2048 sc1
  v_exp_f32 v169, v169
  v_exp_f32 v170, v170
  v_exp_f32 v171, v171
  v_exp_f32 v140, v140
  v_exp_f32 v141, v141
  v_smfmac_f32_32x32x32_bf16 v[188:203], v[224:227], v[164:171], v236
  v_exp_f32 v142, v142
  v_exp_f32 v143, v143
  v_exp_f32 v144, v144
  v_mfma_f32_32x32x16_bf16 v[156:171], v[216:219], v[136:139], 4.0
  v_exp_f32 v145, v145
  v_exp_f32 v146, v146
  v_exp_f32 v147, v147
  v_exp_f32 v148, v148
  v_exp_f32 v149, v149
  s_waitcnt lgkmcnt(0)
  v_smfmac_f32_32x32x32_bf16 v[172:187], v[228:231], v[140:147], v236
  v_exp_f32 v150, v150
  v_exp_f32 v151, v151
  v_exp_f32 v152, v152
  v_add_u32 v239, s53, v238
  s_mov_b64 exec, s[46:47]
  ds_read_b128 v[220:223], v239 offset:0
  ds_read_b128 v[224:227], v239 offset:1024
  s_mov_b64 exec, -1
  v_exp_f32 v153, v153
  v_exp_f32 v154, v154
  v_exp_f32 v155, v155
  v_exp_f32 v156, v156
  v_exp_f32 v157, v157
  v_smfmac_f32_32x32x32_bf16 v[172:187], v[232:235], v[148:155], v236
  v_exp_f32 v158, v158
  v_exp_f32 v159, v159
  v_exp_f32 v160, v160
  s_waitcnt vmcnt(2)
  v_mfma_f32_32x32x16_bf16 v[140:155], v[204:207], v[132:135], 4.0
  v_exp_f32 v161, v161
  v_exp_f32 v162, v162
  v_exp_f32 v163, v163
  v_exp_f32 v164, v164
  v_exp_f32 v165, v165
  v_smfmac_f32_32x32x32_bf16 v[188:203], v[228:231], v[156:163], v236
  v_exp_f32 v166, v166
  v_exp_f32 v167, v167
  v_exp_f32 v168, v168
  buffer_load_dwordx4 v[216:219], v237, s[16:19], s52 offen offset:3072 sc1
  v_exp_f32 v169, v169
  s_add_u32 s54, s54, 4096
  s_and_b32 s54, s54, 0xffff
  s_add_u32 s52, s54, s48
  s_lshl_b32 s53, s54, 1
  v_exp_f32 v170, v170
  v_exp_f32 v171, v171
  v_exp_f32 v140, v140
  v_exp_f32 v141, v141
  v_smfmac_f32_32x32x32_bf16 v[188:203], v[232:235], v[164:171], v236
  v_exp_f32 v142, v142
  v_exp_f32 v143, v143
  v_exp_f32 v144, v144
  v_mfma_f32_32x32x16_bf16 v[156:171], v[204:207], v[136:139], 4.0
  v_exp_f32 v145, v145
  v_exp_f32 v146, v146
  v_exp_f32 v147, v147
  v_exp_f32 v148, v148
  v_exp_f32 v149, v149
  s_waitcnt lgkmcnt(0)
  v_smfmac_f32_32x32x32_bf16 v[172:187], v[220:223], v[140:147], v236
  v_exp_f32 v150, v150
  v_exp_f32 v151, v151
  v_exp_f32 v152, v152
  s_mov_b64 exec, s[46:47]
  ds_read_b128 v[228:231], v239 offset:2048
  ds_read_b128 v[232:235], v239 offset:3072
  s_mov_b64 exec, -1
  v_exp_f32 v153, v153
  v_exp_f32 v154, v154
  v_exp_f32 v155, v155
  v_exp_f32 v156, v156
  v_exp_f32 v157, v157
  v_smfmac_f32_32x32x32_bf16 v[172:187], v[224:227], v[148:155], v236
  v_exp_f32 v158, v158
  v_exp_f32 v159, v159
  v_exp_f32 v160, v160
  s_waitcnt vmcnt(2)
  v_mfma_f32_32x32x16_bf16 v[140:155], v[208:211], v[132:135], 4.0
  v_exp_f32 v161, v161
  v_exp_f32 v162, v162
  v_exp_f32 v163, v163
  v_exp_f32 v164, v164
  v_exp_f32 v165, v165
  v_smfmac_f32_32x32x32_bf16 v[188:203], v[220:223], v[156:163], v236
  v_exp_f32 v166, v166
  v_exp_f32 v167, v167
  v_exp_f32 v168, v168
  buffer_load_dwordx4 v[204:207], v237, s[16:19], s52 offen offset:0 sc1
  v_exp_f32 v169, v169
  v_exp_f32 v170, v170
  v_exp_f32 v171, v171
  v_exp_f32 v140, v140
  v_exp_f32 v141, v141
  v_smfmac_f32_32x32x32_bf16 v[188:203], v[224:227], v[164:171], v236
  v_exp_f32 v142, v142
  v_exp_f32 v143, v143
  v_exp_f32 v144, v144
  v_mfma_f32_32x32x16_bf16 v[156:171], v[208:211], v[136:139], 4.0
  v_exp_f32 v145, v145
  v_exp_f32 v146, v146
  v_exp_f32 v147, v147
  v_exp_f32 v148, v148
  v_exp_f32 v149, v149
  s_waitcnt lgkmcnt(0)
  v_smfmac_f32_32x32x32_bf16 v[172:187], v[228:231], v[140:147], v236
  v_exp_f32 v150, v150
  v_exp_f32 v151, v151
  v_exp_f32 v152, v152
  s_mov_b64 exec, s[46:47]
  ds_read_b128 v[220:223], v239 offset:4096
  ds_read_b128 v[224:227], v239 offset:5120
  s_mov_b64 exec, -1
  v_exp_f32 v153, v153
  v_exp_f32 v154, v154
  v_exp_f32 v155, v155
  v_exp_f32 v156, v156
  v_exp_f32 v157, v157
  v_smfmac_f32_32x32x32_bf16 v[172:187], v[232:235], v[148:155], v236
  v_exp_f32 v158, v158
  v_exp_f32 v159, v159
  v_exp_f32 v160, v160
  s_waitcnt vmcnt(2)
  v_mfma_f32_32x32x16_bf16 v[140:155], v[212:215], v[132:135], 4.0
  v_exp_f32 v161, v161
  v_exp_f32 v162, v162
  v_exp_f32 v163, v163
  v_exp_f32 v164, v164
  v_exp_f32 v165, v165
  v_smfmac_f32_32x32x32_bf16 v[188:203], v[228:231], v[156:163], v236
  v_exp_f32 v166, v166
  v_exp_f32 v167, v167
  v_exp_f32 v168, v168
  buffer_load_dwordx4 v[208:211], v237, s[16:19], s52 offen offset:1024 sc1
  v_exp_f32 v169, v169
  v_exp_f32 v170, v170
  v_exp_f32 v171, v171
  v_exp_f32 v140, v140
  v_exp_f32 v141, v141
  v_smfmac_f32_32x32x32_bf16 v[188:203], v[232:235], v[164:171], v236
  v_exp_f32 v142, v142
  v_exp_f32 v143, v143
  v_exp_f32 v144, v144
  v_mfma_f32_32x32x16_bf16 v[156:171], v[212:215], v[136:139], 4.0
  v_exp_f32 v145, v145
  v_exp_f32 v146, v146
  v_exp_f32 v147, v147
  v_exp_f32 v148, v148
  v_exp_f32 v149, v149
  s_waitcnt lgkmcnt(0)
  v_smfmac_f32_32x32x32_bf16 v[172:187], v[220:223], v[140:147], v236
  v_exp_f32 v150, v150
  v_exp_f32 v151, v151
  v_exp_f32 v152, v152
  s_mov_b64 exec, s[46:47]
  ds_read_b128 v[228:231], v239 offset:6144
  ds_read_b128 v[232:235], v239 offset:7168
  s_mov_b64 exec, -1
  v_exp_f32 v153, v153
  v_exp_f32 v154, v154
  v_exp_f32 v155, v155
  v_exp_f32 v156, v156
  v_exp_f32 v157, v157
  v_smfmac_f32_32x32x32_bf16 v[172:187], v[224:227], v[148:155], v236
  v_exp_f32 v158, v158
  v_exp_f32 v159, v159
  v_exp_f32 v160, v160
  s_waitcnt vmcnt(2)
  v_mfma_f32_32x32x16_bf16 v[140:155], v[216:219], v[132:135], 4.0
  v_exp_f32 v161, v161
  v_exp_f32 v162, v162
  v_exp_f32 v163, v163
  v_exp_f32 v164, v164
  v_exp_f32 v165, v165
  v_smfmac_f32_32x32x32_bf16 v[188:203], v[220:223], v[156:163], v236
  v_exp_f32 v166, v166
  v_exp_f32 v167, v167
  v_exp_f32 v168, v168
  buffer_load_dwordx4 v[212:215], v237, s[16:19], s52 offen offset:2048 sc1
  v_exp_f32 v169, v169
  v_exp_f32 v170, v170
  v_exp_f32 v171, v171
  v_exp_f32 v140, v140
  v_exp_f32 v141, v141
  v_smfmac_f32_32x32x32_bf16 v[188:203], v[224:227], v[164:171], v236
  v_exp_f32 v142, v142
  v_exp_f32 v143, v143
  v_exp_f32 v144, v144
  v_mfma_f32_32x32x16_bf16 v[156:171], v[216:219], v[136:139], 4.0
  v_exp_f32 v145, v145
  v_exp_f32 v146, v146
  v_exp_f32 v147, v147
  v_exp_f32 v148, v148
  v_exp_f32 v149, v149
  s_waitcnt lgkmcnt(0)
  v_smfmac_f32_32x32x32_bf16 v[172:187], v[228:231], v[140:147], v236
  v_exp_f32 v150, v150
  v_exp_f32 v151, v151
  v_exp_f32 v152, v152
  v_add_u32 v239, s53, v238
  s_mov_b64 exec, s[46:47]
  ds_read_b128 v[220:223], v239 offset:0
  ds_read_b128 v[224:227], v239 offset:1024
  s_mov_b64 exec, -1
  v_exp_f32 v153, v153
  v_exp_f32 v154, v154
  v_exp_f32 v155, v155
  v_exp_f32 v156, v156
  v_exp_f32 v157, v157
  v_smfmac_f32_32x32x32_bf16 v[172:187], v[232:235], v[148:155], v236
  v_exp_f32 v158, v158
  v_exp_f32 v159, v159
  v_exp_f32 v160, v160
  s_waitcnt vmcnt(2)
  v_mfma_f32_32x32x16_bf16 v[140:155], v[204:207], v[132:135], 4.0
  v_exp_f32 v161, v161
  v_exp_f32 v162, v162
  v_exp_f32 v163, v163
  v_exp_f32 v164, v164
  v_exp_f32 v165, v165
  v_smfmac_f32_32x32x32_bf16 v[188:203], v[228:231], v[156:163], v236
  v_exp_f32 v166, v166
  v_exp_f32 v167, v167
  v_exp_f32 v168, v168
  buffer_load_dwordx4 v[216:219], v237, s[16:19], s52 offen offset:3072 sc1
  v_exp_f32 v169, v169
  s_add_u32 s54, s54, 4096
  s_and_b32 s54, s54, 0xffff
  s_add_u32 s52, s54, s48
  s_lshl_b32 s53, s54, 1
  v_exp_f32 v170, v170
  v_exp_f32 v171, v171
  v_exp_f32 v140, v140
  v_exp_f32 v141, v141
  v_smfmac_f32_32x32x32_bf16 v[188:203], v[232:235], v[164:171], v236
  v_exp_f32 v142, v142
  v_exp_f32 v143, v143
  v_exp_f32 v144, v144
  v_mfma_f32_32x32x16_bf16 v[156:171], v[204:207], v[136:139], 4.0
  v_exp_f32 v145, v145
  v_exp_f32 v146, v146
  v_exp_f32 v147, v147
  v_exp_f32 v148, v148
  v_exp_f32 v149, v149
  s_waitcnt lgkmcnt(0)
  v_smfmac_f32_32x32x32_bf16 v[172:187], v[220:223], v[140:147], v236
  v_exp_f32 v150, v150
  v_exp_f32 v151, v151
  v_exp_f32 v152, v152
  s_mov_b64 exec, s[46:47]
  ds_read_b128 v[228:231], v239 offset:2048
  ds_read_b128 v[232:235], v239 offset:3072
  s_mov_b64 exec, -1
  v_exp_f32 v153, v153
  v_exp_f32 v154, v154
  v_exp_f32 v155, v155
  v_exp_f32 v156, v156
  v_exp_f32 v157, v157
  v_smfmac_f32_32x32x32_bf16 v[172:187], v[224:227], v[148:155], v236
  v_exp_f32 v158, v158
  v_exp_f32 v159, v159
  v_exp_f32 v160, v160
  s_waitcnt vmcnt(2)
  v_mfma_f32_32x32x16_bf16 v[140:155], v[208:211], v[132:135], 4.0
  v_exp_f32 v161, v161
  v_exp_f32 v162, v162
  v_exp_f32 v163, v163
  v_exp_f32 v164, v164
  v_exp_f32 v165, v165
  v_smfmac_f32_32x32x32_bf16 v[188:203], v[220:223], v[156:163], v236
  v_exp_f32 v166, v166
  v_exp_f32 v167, v167
  v_exp_f32 v168, v168
  v_exp_f32 v169, v169
  v_exp_f32 v170, v170
  v_exp_f32 v171, v171
  v_exp_f32 v140, v140
  v_exp_f32 v141, v141
  v_smfmac_f32_32x32x32_bf16 v[188:203], v[224:227], v[164:171], v236
  v_exp_f32 v142, v142
  v_exp_f32 v143, v143
  v_exp_f32 v144, v144
  v_mfma_f32_32x32x16_bf16 v[156:171], v[208:211], v[136:139], 4.0
  v_exp_f32 v145, v145
  v_exp_f32 v146, v146
  v_exp_f32 v147, v147
  v_exp_f32 v148, v148
  v_exp_f32 v149, v149
  s_waitcnt lgkmcnt(0)
  v_smfmac_f32_32x32x32_bf16 v[172:187], v[228:231], v[140:147], v236
  v_exp_f32 v150, v150
  v_exp_f32 v151, v151
  v_exp_f32 v152, v152
  s_mov_b64 exec, s[46:47]
  ds_read_b128 v[220:223], v239 offset:4096
  ds_read_b128 v[224:227], v239 offset:5120
  s_mov_b64 exec, -1
  v_exp_f32 v153, v153
  v_exp_f32 v154, v154
  v_exp_f32 v155, v155
  v_exp_f32 v156, v156
  v_exp_f32 v157, v157
  v_smfmac_f32_32x32x32_bf16 v[172:187], v[232:235], v[148:155], v236
  v_exp_f32 v158, v158
  v_exp_f32 v159, v159
  v_exp_f32 v160, v160
  s_waitcnt vmcnt(1)
  v_mfma_f32_32x32x16_bf16 v[140:155], v[212:215], v[132:135], 4.0
  v_exp_f32 v161, v161
  v_exp_f32 v162, v162
  v_exp_f32 v163, v163
  v_exp_f32 v164, v164
  v_exp_f32 v165, v165
  v_smfmac_f32_32x32x32_bf16 v[188:203], v[228:231], v[156:163], v236
  v_exp_f32 v166, v166
  v_exp_f32 v167, v167
  v_exp_f32 v168, v168
  v_exp_f32 v169, v169
  v_exp_f32 v170, v170
  v_exp_f32 v171, v171
  v_exp_f32 v140, v140
  v_exp_f32 v141, v141
  v_smfmac_f32_32x32x32_bf16 v[188:203], v[232:235], v[164:171], v236
  v_exp_f32 v142, v142
  v_exp_f32 v143, v143
  v_exp_f32 v144, v144
  v_mfma_f32_32x32x16_bf16 v[156:171], v[212:215], v[136:139], 4.0
  v_exp_f32 v145, v145
  v_exp_f32 v146, v146
  v_exp_f32 v147, v147
  v_exp_f32 v148, v148
  v_exp_f32 v149, v149
  s_waitcnt lgkmcnt(0)
  v_smfmac_f32_32x32x32_bf16 v[172:187], v[220:223], v[140:147], v236
  v_exp_f32 v150, v150
  v_exp_f32 v151, v151
  v_exp_f32 v152, v152
  s_mov_b64 exec, s[46:47]
  ds_read_b128 v[228:231], v239 offset:6144
  ds_read_b128 v[232:235], v239 offset:7168
  s_mov_b64 exec, -1
  v_exp_f32 v153, v153
  v_exp_f32 v154, v154
  v_exp_f32 v155, v155
  v_exp_f32 v156, v156
  v_exp_f32 v157, v157
  v_smfmac_f32_32x32x32_bf16 v[172:187], v[224:227], v[148:155], v236
  v_exp_f32 v158, v158
  v_exp_f32 v159, v159
  v_exp_f32 v160, v160
  s_waitcnt vmcnt(0)
  v_mfma_f32_32x32x16_bf16 v[140:155], v[216:219], v[132:135], 4.0
  v_exp_f32 v161, v161
  v_exp_f32 v162, v162
  v_exp_f32 v163, v163
  v_exp_f32 v164, v164
  v_exp_f32 v165, v165
  v_smfmac_f32_32x32x32_bf16 v[188:203], v[220:223], v[156:163], v236
  v_exp_f32 v166, v166
  v_exp_f32 v167, v167
  v_exp_f32 v168, v168
  v_exp_f32 v169, v169
  v_exp_f32 v170, v170
  v_exp_f32 v171, v171
  v_exp_f32 v140, v140
  v_exp_f32 v141, v141
  v_smfmac_f32_32x32x32_bf16 v[188:203], v[224:227], v[164:171], v236
  v_exp_f32 v142, v142
  v_exp_f32 v143, v143
  v_exp_f32 v144, v144
  v_mfma_f32_32x32x16_bf16 v[156:171], v[216:219], v[136:139], 4.0
  v_exp_f32 v145, v145
  v_exp_f32 v146, v146
  v_exp_f32 v147, v147
  v_exp_f32 v148, v148
  v_exp_f32 v149, v149
  s_waitcnt lgkmcnt(0)
  v_smfmac_f32_32x32x32_bf16 v[172:187], v[228:231], v[140:147], v236
  v_exp_f32 v150, v150
  v_exp_f32 v151, v151
  v_exp_f32 v152, v152
  v_exp_f32 v153, v153
  v_exp_f32 v154, v154
  v_exp_f32 v155, v155
  v_exp_f32 v156, v156
  v_exp_f32 v157, v157
  v_smfmac_f32_32x32x32_bf16 v[172:187], v[232:235], v[148:155], v236
  v_exp_f32 v158, v158
  v_exp_f32 v159, v159
  v_exp_f32 v160, v160
  v_exp_f32 v161, v161
  v_exp_f32 v162, v162
  v_exp_f32 v163, v163
  v_exp_f32 v164, v164
  v_exp_f32 v165, v165
  v_smfmac_f32_32x32x32_bf16 v[188:203], v[228:231], v[156:163], v236
  v_exp_f32 v166, v166
  v_exp_f32 v167, v167
  v_exp_f32 v168, v168
  v_exp_f32 v169, v169
  v_exp_f32 v170, v170
  v_exp_f32 v171, v171
  s_nop 1
  v_smfmac_f32_32x32x32_bf16 v[188:203], v[232:235], v[164:171], v236
  s_mov_b32 s29, 0x17800000
  s_mov_b32 s30, 0x76800000
  s_mov_b32 s31, 0x7f800000
  v_cmp_le_f32 s[58:59], s29, v180
  v_cmp_ge_f32 vcc, s30, v180
  v_add_f32 v248, abs(v172), abs(v173)
  v_add_f32 v248, v248, abs(v174)
  v_add_f32 v248, v248, abs(v175)
  v_add_f32 v248, v248, abs(v176)
  v_add_f32 v248, v248, abs(v177)
  v_add_f32 v248, v248, abs(v178)
  v_add_f32 v248, v248, abs(v179)
  s_and_b64 s[58:59], s[58:59], vcc
  v_cmp_le_f32 vcc, s29, v196
  v_add_f32 v248, v248, abs(v188)
  v_add_f32 v248, v248, abs(v189)
  v_add_f32 v248, v248, abs(v190)
  v_add_f32 v248, v248, abs(v191)
  v_add_f32 v248, v248, abs(v192)
  v_add_f32 v248, v248, abs(v193)
  v_add_f32 v248, v248, abs(v194)
  v_add_f32 v248, v248, abs(v195)
  s_and_b64 s[58:59], s[58:59], vcc
  v_cmp_ge_f32 vcc, s30, v196
  s_nop 1
  s_and_b64 s[58:59], s[58:59], vcc
  v_cmp_gt_f32 vcc, s31, v248
  s_nop 1
  s_and_b64 s[58:59], s[58:59], vcc
  s_cmp_eq_u64 s[58:59], -1
  s_cbranch_scc0 att_fallback
att_finish:
  v_rcp_f32 v248, v180
  v_rcp_f32 v249, v196
  s_mov_b32 s29, -2
  v_mul_f32 v172, v172, v248
  v_mul_f32 v173, v173, v248
  v_mul_f32 v174, v174, v248
  v_mul_f32 v175, v175, v248
  v_mul_f32 v176, v176, v248
  v_mul_f32 v177, v177, v248
  v_mul_f32 v178, v178, v248
  v_mul_f32 v179, v179, v248
  v_cvt_pk_bf16_f32 v140, v172, v173
  v_cvt_pk_bf16_f32 v141, v174, v175
  v_cvt_pk_bf16_f32 v142, v176, v177
  v_cvt_pk_bf16_f32 v143, v178, v179
  v_min_u32 v140, s29, v140
  v_min_u32 v141, s29, v141
  v_min_u32 v142, s29, v142
  v_min_u32 v143, s29, v143
  s_cmp_lg_u32 s43, 0
  s_cbranch_scc1 att_ofast0
  buffer_store_dwordx4 v[140:143], v242, s[16:19], s4 offen sc1
  s_branch att_odone0
att_ofast0:
  buffer_store_dwordx4 v[140:143], v242, s[16:19], s4 offen
att_odone0:
  v_mul_f32 v188, v188, v249
  v_mul_f32 v189, v189, v249
  v_mul_f32 v190, v190, v249
  v_mul_f32 v191, v191, v249
  v_mul_f32 v192, v192, v249
  v_mul_f32 v193, v193, v249
  v_mul_f32 v194, v194, v249
  v_mul_f32 v195, v195, v249
  v_cvt_pk_bf16_f32 v144, v188, v189
  v_cvt_pk_bf16_f32 v145, v190, v191
  v_cvt_pk_bf16_f32 v146, v192, v193
  v_cvt_pk_bf16_f32 v147, v194, v195
  v_min_u32 v144, s29, v144
  v_min_u32 v145, s29, v145
  v_min_u32 v146, s29, v146
  v_min_u32 v147, s29, v147
  s_cmp_lg_u32 s43, 0
  s_cbranch_scc1 att_ofast1
  buffer_store_dwordx4 v[144:147], v242, s[16:19], s5 offen sc1
  s_branch att_odone1
att_ofast1:
  buffer_store_dwordx4 v[144:147], v242, s[16:19], s5 offen
att_odone1:
  s_lshr_b32 s29, s25, 1
  s_lshl_b32 s30, s26, 3
  s_add_u32 s44, s29, s30
  s_lshl_b32 s30, s24, 6
  s_add_u32 s30, s30, s44
  s_lshl_b32 s30, s30, 15
  s_lshl_b32 s31, s3, 12
  s_add_u32 s30, s30, s31
  s_add_u32 s45, s30, 8388608
  buffer_load_dwordx4 v[204:207], v237, s[16:19], s45 offen offset:0 sc1
  buffer_load_dwordx4 v[208:211], v237, s[16:19], s45 offen offset:1024 sc1
  buffer_load_dwordx4 v[212:215], v237, s[16:19], s45 offen offset:2048 sc1
  buffer_load_dwordx4 v[216:219], v237, s[16:19], s45 offen offset:3072 sc1
  v_add_u32 v250, s6, v237
  v_add_u32 v251, 131072, v237
  v_and_b32 v252, 15, v0
  v_lshlrev_b32 v252, 11, v252
  v_bfe_u32 v249, v0, 4, 1
  v_lshl_add_u32 v252, v249, 5, v252
  v_lshrrev_b32 v249, 5, v0
  v_lshl_add_u32 v252, v249, 4, v252
  s_lshl_b32 s29, s44, 16
  s_lshl_b32 s30, s24, 10
  s_add_u32 s29, s29, s30
  s_add_u32 s52, s29, s7
  s_add_u32 s53, s52, 32768
  s_waitcnt vmcnt(0)
  v_max3_u32 v248, v204, v205, v206
  v_max3_u32 v248, v248, v207, v208
  v_max3_u32 v248, v248, v209, v210
  v_max3_u32 v248, v248, v211, v212
  v_max3_u32 v248, v248, v213, v214
  v_max3_u32 v248, v248, v215, v216
  v_max3_u32 v248, v248, v217, v218
  v_max_u32 v248, v248, v219
  v_cmp_ne_u32 vcc, -1, v248
  s_nop 1
  s_cmp_eq_u64 vcc, -1
  s_cbranch_scc1 prj_ok
  s_mov_b32 s98, 0
prj_spin:
  s_add_u32 s98, s98, 1
  s_cmp_gt_u32 s98, 0x1000000
  s_cbranch_scc1 prj_ok
  buffer_load_dwordx4 v[204:207], v237, s[16:19], s45 offen offset:0 sc1
  buffer_load_dwordx4 v[208:211], v237, s[16:19], s45 offen offset:1024 sc1
  buffer_load_dwordx4 v[212:215], v237, s[16:19], s45 offen offset:2048 sc1
  buffer_load_dwordx4 v[216:219], v237, s[16:19], s45 offen offset:3072 sc1
  s_waitcnt vmcnt(0)
  v_max3_u32 v248, v204, v205, v206
  v_max3_u32 v248, v248, v207, v208
  v_max3_u32 v248, v248, v209, v210
  v_max3_u32 v248, v248, v211, v212
  v_max3_u32 v248, v248, v213, v214
  v_max3_u32 v248, v248, v215, v216
  v_max3_u32 v248, v248, v217, v218
  v_max_u32 v248, v248, v219
  v_cmp_ne_u32 vcc, -1, v248
  s_nop 1
  s_cmp_eq_u64 vcc, -1
  s_cbranch_scc0 prj_spin
prj_ok:
  ds_write_b128 v250, v[204:207] offset:0
  ds_write_b128 v250, v[208:211] offset:1024
  ds_write_b128 v250, v[212:215] offset:2048
  ds_write_b128 v250, v[216:219] offset:3072
  s_waitcnt lgkmcnt(0)
  s_barrier
  ds_read_b128 v[220:223], v251 offset:0
  ds_read_b128 v[224:227], v251 offset:2048
  ds_read_b128 v[228:231], v251 offset:4096
  ds_read_b128 v[232:235], v251 offset:6144
  ds_read_b128 v[156:159], v251 offset:8192
  ds_read_b128 v[160:163], v251 offset:10240
  ds_read_b128 v[164:167], v251 offset:12288
  ds_read_b128 v[168:171], v251 offset:14336
  ds_read_b128 v[204:207], v251 offset:16384
  ds_read_b128 v[208:211], v251 offset:18432
  ds_read_b128 v[212:215], v251 offset:20480
  ds_read_b128 v[216:219], v251 offset:22528
  s_waitcnt lgkmcnt(8)
  v_mfma_f32_16x16x32_bf16 v[172:175], v[4:7], v[220:223], 0
  v_mfma_f32_16x16x32_bf16 v[176:179], v[8:11], v[220:223], 0
  ds_read_b128 v[188:191], v251 offset:24576
  v_mfma_f32_16x16x32_bf16 v[172:175], v[12:15], v[224:227], v[172:175]
  v_mfma_f32_16x16x32_bf16 v[176:179], v[16:19], v[224:227], v[176:179]
  ds_read_b128 v[192:195], v251 offset:26624
  v_mfma_f32_16x16x32_bf16 v[172:175], v[20:23], v[228:231], v[172:175]
  v_mfma_f32_16x16x32_bf16 v[176:179], v[24:27], v[228:231], v[176:179]
  ds_read_b128 v[196:199], v251 offset:28672
  v_mfma_f32_16x16x32_bf16 v[172:175], v[28:31], v[232:235], v[172:175]
  v_mfma_f32_16x16x32_bf16 v[176:179], v[32:35], v[232:235], v[176:179]
  ds_read_b128 v[200:203], v251 offset:30720
  s_waitcnt lgkmcnt(8)
  v_mfma_f32_16x16x32_bf16 v[172:175], v[36:39], v[156:159], v[172:175]
  v_mfma_f32_16x16x32_bf16 v[176:179], v[40:43], v[156:159], v[176:179]
  ds_read_b128 v[220:223], v251 offset:1024
  v_mfma_f32_16x16x32_bf16 v[172:175], v[44:47], v[160:163], v[172:175]
  v_mfma_f32_16x16x32_bf16 v[176:179], v[48:51], v[160:163], v[176:179]
  ds_read_b128 v[224:227], v251 offset:3072
  v_mfma_f32_16x16x32_bf16 v[172:175], v[52:55], v[164:167], v[172:175]
  v_mfma_f32_16x16x32_bf16 v[176:179], v[56:59], v[164:167], v[176:179]
  ds_read_b128 v[228:231], v251 offset:5120
  v_mfma_f32_16x16x32_bf16 v[172:175], v[60:63], v[168:171], v[172:175]
  v_mfma_f32_16x16x32_bf16 v[176:179], v[64:67], v[168:171], v[176:179]
  ds_read_b128 v[232:235], v251 offset:7168
  s_waitcnt lgkmcnt(8)
  v_mfma_f32_16x16x32_bf16 v[172:175], v[68:71], v[204:207], v[172:175]
  v_mfma_f32_16x16x32_bf16 v[176:179], v[72:75], v[204:207], v[176:179]
  ds_read_b128 v[156:159], v251 offset:9216
  v_mfma_f32_16x16x32_bf16 v[172:175], v[76:79], v[208:211], v[172:175]
  v_mfma_f32_16x16x32_bf16 v[176:179], v[80:83], v[208:211], v[176:179]
  ds_read_b128 v[160:163], v251 offset:11264
  v_mfma_f32_16x16x32_bf16 v[172:175], v[84:87], v[212:215], v[172:175]
  v_mfma_f32_16x16x32_bf16 v[176:179], v[88:91], v[212:215], v[176:179]
  ds_read_b128 v[164:167], v251 offset:13312
  v_mfma_f32_16x16x32_bf16 v[172:175], v[92:95], v[216:219], v[172:175]
  v_mfma_f32_16x16x32_bf16 v[176:179], v[96:99], v[216:219], v[176:179]
  ds_read_b128 v[168:171], v251 offset:15360
  s_waitcnt lgkmcnt(8)
  v_mfma_f32_16x16x32_bf16 v[172:175], v[100:103], v[188:191], v[172:175]
  v_mfma_f32_16x16x32_bf16 v[176:179], v[104:107], v[188:191], v[176:179]
  ds_read_b128 v[204:207], v251 offset:17408
  v_mfma_f32_16x16x32_bf16 v[172:175], v[108:111], v[192:195], v[172:175]
  v_mfma_f32_16x16x32_bf16 v[176:179], v[112:115], v[192:195], v[176:179]
  ds_read_b128 v[208:211], v251 offset:19456
  v_mfma_f32_16x16x32_bf16 v[172:175], v[116:119], v[196:199], v[172:175]
  v_mfma_f32_16x16x32_bf16 v[176:179], v[120:123], v[196:199], v[176:179]
  ds_read_b128 v[212:215], v251 offset:21504
  v_mfma_f32_16x16x32_bf16 v[172:175], v[124:127], v[200:203], v[172:175]
  v_mfma_f32_16x16x32_bf16 v[176:179], v[128:131], v[200:203], v[176:179]
  ds_read_b128 v[216:219], v251 offset:23552
  s_waitcnt lgkmcnt(8)
  v_mfma_f32_16x16x32_bf16 v[180:183], v[4:7], v[220:223], 0
  v_mfma_f32_16x16x32_bf16 v[184:187], v[8:11], v[220:223], 0
  ds_read_b128 v[188:191], v251 offset:25600
  v_mfma_f32_16x16x32_bf16 v[180:183], v[12:15], v[224:227], v[180:183]
  v_mfma_f32_16x16x32_bf16 v[184:187], v[16:19], v[224:227], v[184:187]
  ds_read_b128 v[192:195], v251 offset:27648
  v_mfma_f32_16x16x32_bf16 v[180:183], v[20:23], v[228:231], v[180:183]
  v_mfma_f32_16x16x32_bf16 v[184:187], v[24:27], v[228:231], v[184:187]
  ds_read_b128 v[196:199], v251 offset:29696
  v_mfma_f32_16x16x32_bf16 v[180:183], v[28:31], v[232:235], v[180:183]
  v_mfma_f32_16x16x32_bf16 v[184:187], v[32:35], v[232:235], v[184:187]
  ds_read_b128 v[200:203], v251 offset:31744
  s_waitcnt lgkmcnt(8)
  v_mfma_f32_16x16x32_bf16 v[180:183], v[36:39], v[156:159], v[180:183]
  v_mfma_f32_16x16x32_bf16 v[184:187], v[40:43], v[156:159], v[184:187]
  v_mfma_f32_16x16x32_bf16 v[180:183], v[44:47], v[160:163], v[180:183]
  v_mfma_f32_16x16x32_bf16 v[184:187], v[48:51], v[160:163], v[184:187]
  v_mfma_f32_16x16x32_bf16 v[180:183], v[52:55], v[164:167], v[180:183]
  v_mfma_f32_16x16x32_bf16 v[184:187], v[56:59], v[164:167], v[184:187]
  v_mfma_f32_16x16x32_bf16 v[180:183], v[60:63], v[168:171], v[180:183]
  v_mfma_f32_16x16x32_bf16 v[184:187], v[64:67], v[168:171], v[184:187]
  s_waitcnt lgkmcnt(4)
  v_mfma_f32_16x16x32_bf16 v[180:183], v[68:71], v[204:207], v[180:183]
  v_mfma_f32_16x16x32_bf16 v[184:187], v[72:75], v[204:207], v[184:187]
  v_cvt_pk_bf16_f32 v140, v172, v173
  v_cvt_pk_bf16_f32 v141, v174, v175
  v_mfma_f32_16x16x32_bf16 v[180:183], v[76:79], v[208:211], v[180:183]
  v_mfma_f32_16x16x32_bf16 v[184:187], v[80:83], v[208:211], v[184:187]
  v_cvt_pk_bf16_f32 v142, v176, v177
  v_cvt_pk_bf16_f32 v143, v178, v179
  v_mfma_f32_16x16x32_bf16 v[180:183], v[84:87], v[212:215], v[180:183]
  v_mfma_f32_16x16x32_bf16 v[184:187], v[88:91], v[212:215], v[184:187]
  s_nop 1
  v_permlane16_swap_b32 v140, v142
  v_mfma_f32_16x16x32_bf16 v[180:183], v[92:95], v[216:219], v[180:183]
  v_mfma_f32_16x16x32_bf16 v[184:187], v[96:99], v[216:219], v[184:187]
  v_permlane16_swap_b32 v141, v143
  buffer_store_dwordx4 v[140:143], v252, s[20:23], s52 offen sc1
  s_waitcnt lgkmcnt(0)
  v_mfma_f32_16x16x32_bf16 v[180:183], v[100:103], v[188:191], v[180:183]
  v_mfma_f32_16x16x32_bf16 v[184:187], v[104:107], v[188:191], v[184:187]
  v_mfma_f32_16x16x32_bf16 v[180:183], v[108:111], v[192:195], v[180:183]
  v_mfma_f32_16x16x32_bf16 v[184:187], v[112:115], v[192:195], v[184:187]
  v_mfma_f32_16x16x32_bf16 v[180:183], v[116:119], v[196:199], v[180:183]
  v_mfma_f32_16x16x32_bf16 v[184:187], v[120:123], v[196:199], v[184:187]
  v_mfma_f32_16x16x32_bf16 v[180:183], v[124:127], v[200:203], v[180:183]
  v_mfma_f32_16x16x32_bf16 v[184:187], v[128:131], v[200:203], v[184:187]
  s_nop 7
  v_cvt_pk_bf16_f32 v144, v180, v181
  v_cvt_pk_bf16_f32 v145, v182, v183
  v_cvt_pk_bf16_f32 v146, v184, v185
  v_cvt_pk_bf16_f32 v147, v186, v187
  s_nop 1
  v_permlane16_swap_b32 v144, v146
  v_permlane16_swap_b32 v145, v147
  buffer_store_dwordx4 v[144:147], v252, s[20:23], s53 offen sc1
concat_heads__mha_block__softmax_full_mha__prompt_kernel_end:
  s_endpgm
att_fallback:
  s_waitcnt vmcnt(0) lgkmcnt(0)
  s_setprio 0
  v_mov_b32 v248, 0xff800000
  s_mov_b32 s56, 0
fb_maxa:
  s_lshl_b32 s29, s56, 10
  s_add_u32 s29, s29, s48
  buffer_load_dwordx4 v[204:207], v237, s[16:19], s29 offen sc1
  s_waitcnt vmcnt(0)
  v_mfma_f32_32x32x16_bf16 v[140:155], v[204:207], v[132:135], 0
  s_nop 7
  s_nop 7
  v_max3_f32 v248, v248, v140, v141
  v_max3_f32 v248, v248, v142, v143
  v_max3_f32 v248, v248, v144, v145
  v_max3_f32 v248, v248, v146, v147
  v_max3_f32 v248, v248, v148, v149
  v_max3_f32 v248, v248, v150, v151
  v_max3_f32 v248, v248, v152, v153
  v_max3_f32 v248, v248, v154, v155
  s_add_u32 s56, s56, 1
  s_cmp_lt_u32 s56, 64
  s_cbranch_scc1 fb_maxa
  v_mov_b32 v249, v248
  s_nop 1
  v_permlane32_swap_b32 v248, v249
  v_min_f32 v156, -v248, -v249
  v_min_f32 v157, -v248, -v249
  v_min_f32 v158, -v248, -v249
  v_min_f32 v159, -v248, -v249
  v_min_f32 v160, -v248, -v249
  v_min_f32 v161, -v248, -v249
  v_min_f32 v162, -v248, -v249
  v_min_f32 v163, -v248, -v249
  v_min_f32 v164, -v248, -v249
  v_min_f32 v165, -v248, -v249
  v_min_f32 v166, -v248, -v249
  v_min_f32 v167, -v248, -v249
  v_min_f32 v168, -v248, -v249
  v_min_f32 v169, -v248, -v249
  v_min_f32 v170, -v248, -v249
  v_min_f32 v171, -v248, -v249
  v_mov_b32 v172, 0
  v_mov_b32 v173, 0
  v_mov_b32 v174, 0
  v_mov_b32 v175, 0
  v_mov_b32 v176, 0
  v_mov_b32 v177, 0
  v_mov_b32 v178, 0
  v_mov_b32 v179, 0
  v_mov_b32 v180, 0
  v_mov_b32 v181, 0
  v_mov_b32 v182, 0
  v_mov_b32 v183, 0
  v_mov_b32 v184, 0
  v_mov_b32 v185, 0
  v_mov_b32 v186, 0
  v_mov_b32 v187, 0
  s_mov_b32 s56, 0
fb_suma:
  s_lshl_b32 s29, s56, 10
  s_add_u32 s29, s29, s48
  s_lshl_b32 s30, s56, 11
  v_add_u32 v239, s30, v238
  buffer_load_dwordx4 v[204:207], v237, s[16:19], s29 offen sc1
  s_mov_b64 exec, s[46:47]
  ds_read_b128 v[220:223], v239 offset:0
  ds_read_b128 v[224:227], v239 offset:1024
  s_mov_b64 exec, -1
  s_waitcnt vmcnt(0) lgkmcnt(0)
  v_mfma_f32_32x32x16_bf16 v[140:155], v[204:207], v[132:135], v[156:171]
  s_nop 7
  s_nop 7
  v_exp_f32 v140, v140
  v_exp_f32 v141, v141
  v_exp_f32 v142, v142
  v_exp_f32 v143, v143
  v_exp_f32 v144, v144
  v_exp_f32 v145, v145
  v_exp_f32 v146, v146
  v_exp_f32 v147, v147
  v_exp_f32 v148, v148
  v_exp_f32 v149, v149
  v_exp_f32 v150, v150
  v_exp_f32 v151, v151
  v_exp_f32 v152, v152
  v_exp_f32 v153, v153
  v_exp_f32 v154, v154
  v_exp_f32 v155, v155
  s_nop 1
  v_smfmac_f32_32x32x32_bf16 v[172:187], v[220:223], v[140:147], v236
  v_smfmac_f32_32x32x32_bf16 v[172:187], v[224:227], v[148:155], v236
  s_add_u32 s56, s56, 1
  s_cmp_lt_u32 s56, 64
  s_cbranch_scc1 fb_suma
  s_nop 7
  s_nop 7
  v_mov_b32 v248, 0xff800000
  s_mov_b32 s56, 0
fb_maxb:
  s_lshl_b32 s29, s56, 10
  s_add_u32 s29, s29, s48
  buffer_load_dwordx4 v[204:207], v237, s[16:19], s29 offen sc1
  s_waitcnt vmcnt(0)
  v_mfma_f32_32x32x16_bf16 v[140:155], v[204:207], v[136:139], 0
  s_nop 7
  s_nop 7
  v_max3_f32 v248, v248, v140, v141
  v_max3_f32 v248, v248, v142, v143
  v_max3_f32 v248, v248, v144, v145
  v_max3_f32 v248, v248, v146, v147
  v_max3_f32 v248, v248, v148, v149
  v_max3_f32 v248, v248, v150, v151
  v_max3_f32 v248, v248, v152, v153
  v_max3_f32 v248, v248, v154, v155
  s_add_u32 s56, s56, 1
  s_cmp_lt_u32 s56, 64
  s_cbranch_scc1 fb_maxb
  v_mov_b32 v249, v248
  s_nop 1
  v_permlane32_swap_b32 v248, v249
  v_min_f32 v156, -v248, -v249
  v_min_f32 v157, -v248, -v249
  v_min_f32 v158, -v248, -v249
  v_min_f32 v159, -v248, -v249
  v_min_f32 v160, -v248, -v249
  v_min_f32 v161, -v248, -v249
  v_min_f32 v162, -v248, -v249
  v_min_f32 v163, -v248, -v249
  v_min_f32 v164, -v248, -v249
  v_min_f32 v165, -v248, -v249
  v_min_f32 v166, -v248, -v249
  v_min_f32 v167, -v248, -v249
  v_min_f32 v168, -v248, -v249
  v_min_f32 v169, -v248, -v249
  v_min_f32 v170, -v248, -v249
  v_min_f32 v171, -v248, -v249
  v_mov_b32 v188, 0
  v_mov_b32 v189, 0
  v_mov_b32 v190, 0
  v_mov_b32 v191, 0
  v_mov_b32 v192, 0
  v_mov_b32 v193, 0
  v_mov_b32 v194, 0
  v_mov_b32 v195, 0
  v_mov_b32 v196, 0
  v_mov_b32 v197, 0
  v_mov_b32 v198, 0
  v_mov_b32 v199, 0
  v_mov_b32 v200, 0
  v_mov_b32 v201, 0
  v_mov_b32 v202, 0
  v_mov_b32 v203, 0
  s_mov_b32 s56, 0
fb_sumb:
  s_lshl_b32 s29, s56, 10
  s_add_u32 s29, s29, s48
  s_lshl_b32 s30, s56, 11
  v_add_u32 v239, s30, v238
  buffer_load_dwordx4 v[204:207], v237, s[16:19], s29 offen sc1
  s_mov_b64 exec, s[46:47]
  ds_read_b128 v[220:223], v239 offset:0
  ds_read_b128 v[224:227], v239 offset:1024
  s_mov_b64 exec, -1
  s_waitcnt vmcnt(0) lgkmcnt(0)
  v_mfma_f32_32x32x16_bf16 v[140:155], v[204:207], v[136:139], v[156:171]
  s_nop 7
  s_nop 7
  v_exp_f32 v140, v140
  v_exp_f32 v141, v141
  v_exp_f32 v142, v142
  v_exp_f32 v143, v143
  v_exp_f32 v144, v144
  v_exp_f32 v145, v145
  v_exp_f32 v146, v146
  v_exp_f32 v147, v147
  v_exp_f32 v148, v148
  v_exp_f32 v149, v149
  v_exp_f32 v150, v150
  v_exp_f32 v151, v151
  v_exp_f32 v152, v152
  v_exp_f32 v153, v153
  v_exp_f32 v154, v154
  v_exp_f32 v155, v155
  s_nop 1
  v_smfmac_f32_32x32x32_bf16 v[188:203], v[220:223], v[140:147], v236
  v_smfmac_f32_32x32x32_bf16 v[188:203], v[224:227], v[148:155], v236
  s_add_u32 s56, s56, 1
  s_cmp_lt_u32 s56, 64
  s_cbranch_scc1 fb_sumb
  s_nop 7
  s_nop 7
  s_branch att_finish
code_end:
.section .rodata,"a"
.p2align 6
.amdhsa_kernel concat_heads__mha_block__softmax_full_mha__prompt_kernel
  .amdhsa_next_free_vgpr 256
  .amdhsa_next_free_sgpr 102
  .amdhsa_accum_offset 256
  .amdhsa_group_segment_fixed_size 0
  .amdhsa_kernarg_size 72
  .amdhsa_user_sgpr_count 2
  .amdhsa_user_sgpr_kernarg_segment_ptr 1
  .amdhsa_system_sgpr_workgroup_id_x 1
  .amdhsa_float_denorm_mode_32 3
.end_amdhsa_kernel
```
